```python
import torch

def _softmax(x, axis=-1):
    return torch.softmax(x, dim=axis)
def _gelu(x):
    return torch.nn.functional.gelu(x, approximate="tanh")
def _silu(x):
    return torch.nn.functional.silu(x)
def _sigmoid(x):
    return torch.sigmoid(x)
def _layernorm(x, axis=-1, eps=1e-5):
    m = x.mean(dim=axis, keepdim=True)
    v = x.var(dim=axis, keepdim=True, unbiased=False)
    return (x - m) / torch.sqrt(v + eps)
def _scatter_add(tgt, idx, src, axis=0):
    return tgt.clone().index_add_(axis, idx, src)
def _segment_sum(src, seg, n):
    out = torch.zeros((n,) + src.shape[1:], dtype=src.dtype)
    return out.index_add_(0, seg, src)
def _pad(x, pw):
    flat = tuple(v for pair in reversed(pw) for v in pair)
    return torch.nn.functional.pad(x, flat)

kernel_name = 'recurrent_scan__spectral_gfnet__dense_activation_gelu__prompt'

def setup_inputs():

    _w = (lambda a: (lambda t: t.to(torch.bfloat16) if t.is_floating_point() else t)(torch.as_tensor(a)))
    def _A_setup():
        B, S, D = 1, 2048, 640
        Df = D // 2 + 1
        return {
            "x": _w((lambda *s: torch.randn(*s, dtype=torch.bfloat16) * 0.05)(B, S, D)),
            "w_r": _w((lambda *s: torch.randn(*s, dtype=torch.bfloat16) * 3.2)(S, Df) * 0.02),
            "w_i": _w((lambda *s: torch.randn(*s, dtype=torch.bfloat16) * 3.2)(S, Df) * 0.02),
        }
    _A_in = _A_setup()

    def _B_setup():
        B, S, D, F = 1, 2048, 640, 1728
        return {
            "x": _w((lambda *s: torch.randn(*s, dtype=torch.bfloat16) * 0.05)(B, S, D)),
            "w1": _w((lambda *s: torch.randn(*s, dtype=torch.bfloat16) * 3.2)(D, F) * (D ** -0.5)),
            "b1": _w((lambda *s: torch.randn(*s, dtype=torch.bfloat16) * 3.2)(F) * 0.01),
            "w2": _w((lambda *s: torch.randn(*s, dtype=torch.bfloat16) * 0.4)(F, D) * (F ** -0.5)),
            "b2": _w((lambda *s: torch.randn(*s, dtype=torch.bfloat16) * 0.4)(D) * 0.01),
        }
    _B_in = _B_setup()

    return {
        "A_x": _A_in["x"],
        "A_w_r": _A_in["w_r"],
        "A_w_i": _A_in["w_i"],
        "B_x": _B_in["x"],
        "B_w1": _B_in["w1"],
        "B_b1": _B_in["b1"],
        "B_w2": _B_in["w2"],
        "B_b2": _B_in["b2"],
    }

def reference(A_x, A_w_r, A_w_i, B_x, B_w1, B_b1, B_w2, B_b2):
    def _A_ref(x, w_r, w_i):
        B, S, D = x.shape
        X = (lambda x, axes=(-2,-1): torch.fft.rfft2(x.float(), dim=axes))(x, axes=(-2, -1))
        W = w_r + 1j * w_i
        X = X * W
        y = (lambda x, s, axes=(-2,-1): torch.fft.irfft2(x, s=s, dim=axes).to(torch.bfloat16))(X, (S, D), axes=(-2, -1))
        return y

    def _B_ref(x, w1, b1, w2, b2):
        h = torch.einsum("bsd,df->bsf", x, w1) + b1
        h = _gelu(h)
        return torch.einsum("bsf,fd->bsd", h, w2) + b2

    x = A_x
    xn = _layernorm(x, axis=-1)
    s = _A_ref(xn, A_w_r, A_w_i)
    g = _silu(_B_ref(xn, B_w1, B_b1, B_w2, B_b2))
    return x + s * g
```

```asm
; @launch grid=(256,1,1) block=(512,1,1) lds=151552
.amdgcn_target "amdgcn-amd-amdhsa--gfx950"
.text
.p2align 8
text_begin:
.globl recurrent_scan__spectral_gfnet__dense_activation_gelu__prompt_kernel
.p2align 8
.type recurrent_scan__spectral_gfnet__dense_activation_gelu__prompt_kernel,@function
recurrent_scan__spectral_gfnet__dense_activation_gelu__prompt_kernel:
    s_cmp_ge_u32 s2, 256
    s_cbranch_scc1 k_end
    s_load_dwordx16 s[52:67], s[0:1], 0
    s_getpc_b64 s[96:97]
cpf:
    s_lshr_b32 s90, s2, 3
    s_lshl_b32 s90, s90, 13
    s_cmp_ge_u32 s90, text_end-text_begin
    s_cbranch_scc1 cpf_done
    v_lshl_add_u32 v250, v0, 4, s90
    v_min_u32 v250, text_end-text_begin-16, v250
    s_sub_u32 s96, s96, cpf-text_begin
    s_subb_u32 s97, s97, 0
    v_mov_b32 v251, s97
    v_add_co_u32 v250, vcc, s96, v250
    s_nop 1
    v_addc_co_u32 v251, vcc, 0, v251, vcc
    global_load_dwordx4 v[252:255], v[250:251], off
cpf_done:
    v_lshrrev_b32 v1, 6, v0
    s_nop 0
    v_readfirstlane_b32 s3, v1
    s_and_b32 s4, s2, 7
    s_lshr_b32 s5, s2, 3
    s_cmp_ge_u32 s5, 28
    s_cbranch_scc1 k1_fft
k1_gemm:
    s_and_b32 s10, s4, 3
    s_lshl_b32 s10, s10, 2
    s_and_b32 s11, s5, 3
    s_add_u32 s10, s10, s11
    s_lshr_b32 s11, s4, 2
    s_mul_i32 s11, s11, 7
    s_lshr_b32 s28, s5, 2
    s_add_u32 s11, s11, s28
    v_and_b32 v1, 63, v0
    s_cmp_lt_u32 s3, 4
    s_cbranch_scc1 k1_comp
    s_sub_u32 s29, s3, 4
    s_lshl_b32 s31, s11, 8
    v_lshrrev_b32 v2, 3, v1
    v_lshrrev_b32 v3, 4, v1
    v_and_b32 v4, 7, v0
    v_xor_b32 v4, v4, v3
    v_and_b32 v6, 3, v2
    v_and_b32 v2, 4, v2
    v_lshl_add_u32 v6, v2, 8, v6
    v_mul_u32_u24 v6, 1280, v6
    v_lshl_add_u32 v6, v4, 4, v6
    v_xor_b32 v7, 64, v6
    v_add_u32 v7, 5120, v7
    v_lshlrev_b32 v2, 2, v3
    v_and_b32 v4, 15, v0
    v_xor_b32 v4, v4, v2
    v_mul_u32_u24 v8, 3456, v3
    v_lshl_add_u32 v8, v4, 4, v8
    s_cmp_eq_u32 s11, 13
    s_cselect_b32 s33, 8, 0
    v_and_b32 v4, s33, v4
    v_lshl_add_u32 v8, v4, 27, v8
    s_add_u32 s32, s10, s11
    s_and_b32 s32, s32, 3
    s_mul_i32 s32, s32, 5
    s_lshr_b32 s32, s32, 1
    s_lshl_b32 s33, s10, 2
    s_add_u32 s33, s33, s29
    s_mul_i32 s33, s33, 20480
    s_mul_i32 s34, s29, 55296
    s_add_u32 s34, s34, s31
    s_lshl_b32 s35, s29, 12
    s_waitcnt lgkmcnt(0)
    s_mov_b32 s12, s52
    s_mov_b32 s13, s53
    s_mov_b32 s14, 2621440
    s_mov_b32 s15, 0x00020000
    s_mov_b32 s16, s60
    s_mov_b32 s17, s61
    s_mov_b32 s18, 2211840
    s_mov_b32 s19, 0x00020000
    s_lshl_b32 s36, s32, 7
    s_add_u32 s36, s36, s33
    s_mul_i32 s37, s32, 221184
    s_add_u32 s37, s37, s34
    s_add_u32 m0, s35, 0
    s_nop 0
    buffer_load_dwordx4 v6, s[12:15], s36 offen lds
    s_add_u32 m0, s35, 65536
    s_nop 0
    buffer_load_dwordx4 v8, s[16:19], s37 offen lds
    s_add_u32 m0, s35, 1024
    s_nop 0
    buffer_load_dwordx4 v7, s[12:15], s36 offen lds
    s_add_u32 m0, s35, 66560
    s_add_u32 s37, s37, 13824
    buffer_load_dwordx4 v8, s[16:19], s37 offen lds
    s_add_u32 m0, s35, 2048
    s_add_u32 s36, s36, 10240
    buffer_load_dwordx4 v6, s[12:15], s36 offen lds
    s_add_u32 m0, s35, 67584
    s_add_u32 s37, s37, 13824
    buffer_load_dwordx4 v8, s[16:19], s37 offen lds
    s_add_u32 m0, s35, 3072
    s_nop 0
    buffer_load_dwordx4 v7, s[12:15], s36 offen lds
    s_add_u32 m0, s35, 68608
    s_add_u32 s37, s37, 13824
    buffer_load_dwordx4 v8, s[16:19], s37 offen lds
    s_add_u32 s32, s32, 1
    s_cmp_eq_u32 s32, 10
    s_cselect_b32 s32, 0, s32
    s_lshl_b32 s36, s32, 7
    s_add_u32 s36, s36, s33
    s_mul_i32 s37, s32, 221184
    s_add_u32 s37, s37, s34
    s_add_u32 m0, s35, 16384
    s_nop 0
    buffer_load_dwordx4 v6, s[12:15], s36 offen lds
    s_add_u32 m0, s35, 81920
    s_nop 0
    buffer_load_dwordx4 v8, s[16:19], s37 offen lds
    s_add_u32 m0, s35, 17408
    s_nop 0
    buffer_load_dwordx4 v7, s[12:15], s36 offen lds
    s_add_u32 m0, s35, 82944
    s_add_u32 s37, s37, 13824
    buffer_load_dwordx4 v8, s[16:19], s37 offen lds
    s_add_u32 m0, s35, 18432
    s_add_u32 s36, s36, 10240
    buffer_load_dwordx4 v6, s[12:15], s36 offen lds
    s_add_u32 m0, s35, 83968
    s_add_u32 s37, s37, 13824
    buffer_load_dwordx4 v8, s[16:19], s37 offen lds
    s_add_u32 m0, s35, 19456
    s_nop 0
    buffer_load_dwordx4 v7, s[12:15], s36 offen lds
    s_add_u32 m0, s35, 84992
    s_add_u32 s37, s37, 13824
    buffer_load_dwordx4 v8, s[16:19], s37 offen lds
    s_add_u32 s32, s32, 1
    s_cmp_eq_u32 s32, 10
    s_cselect_b32 s32, 0, s32
    v_mov_b32 v5, 0
    v_mov_b32 v9, 0
    v_mov_b32 v78, 150528
    v_mov_b32 v79, 1
    ds_write2_b32 v78, v9, v9 offset0:0 offset1:1
    ds_write2_b32 v78, v9, v9 offset0:2 offset1:3
    s_lshr_b32 s68, s10, 1
    s_lshl_b32 s69, s68, 12
    s_lshl_b32 s68, s68, 8
    s_add_u32 s68, s68, 25600
    s_and_b32 s44, s10, 1
    s_lshl_b32 s44, s44, 6
    s_add_u32 s69, s69, s44
    v_and_b32 v2, 31, v0
    v_lshlrev_b32 v24, 7, v2
    v_and_b32 v2, 32, v0
    v_add_u32 v24, v24, v2
    v_lshlrev_b32 v25, 4, v1
    v_add_u32 v25, 148480, v25
    v_and_b32 v11, 3, v0
    v_lshlrev_b32 v11, 6, v11
    s_waitcnt vmcnt(8)
    s_barrier
    s_lshl_b32 s36, s32, 7
    s_add_u32 s36, s36, s33
    s_mul_i32 s37, s32, 221184
    s_add_u32 s37, s37, s34
    s_add_u32 m0, s35, 32768
    s_nop 0
    buffer_load_dwordx4 v6, s[12:15], s36 offen lds
    s_add_u32 m0, s35, 98304
    s_nop 0
    buffer_load_dwordx4 v8, s[16:19], s37 offen lds
    s_add_u32 m0, s35, 33792
    s_nop 0
    buffer_load_dwordx4 v7, s[12:15], s36 offen lds
    s_add_u32 m0, s35, 99328
    s_add_u32 s37, s37, 13824
    buffer_load_dwordx4 v8, s[16:19], s37 offen lds
    s_add_u32 m0, s35, 34816
    s_add_u32 s36, s36, 10240
    buffer_load_dwordx4 v6, s[12:15], s36 offen lds
    s_add_u32 m0, s35, 100352
    s_add_u32 s37, s37, 13824
    buffer_load_dwordx4 v8, s[16:19], s37 offen lds
    s_add_u32 m0, s35, 35840
    s_nop 0
    buffer_load_dwordx4 v7, s[12:15], s36 offen lds
    s_add_u32 m0, s35, 101376
    s_add_u32 s37, s37, 13824
    buffer_load_dwordx4 v8, s[16:19], s37 offen lds
    s_add_u32 s32, s32, 1
    s_cmp_eq_u32 s32, 10
    s_cselect_b32 s32, 0, s32
    s_lshl_b32 s36, s32, 7
    s_add_u32 s36, s36, s33
    s_mul_i32 s37, s32, 221184
    s_add_u32 s37, s37, s34
    s_add_u32 m0, s35, 49152
    s_nop 0
    buffer_load_dwordx4 v6, s[12:15], s36 offen lds
    s_add_u32 m0, s35, 114688
    s_nop 0
    buffer_load_dwordx4 v8, s[16:19], s37 offen lds
    s_add_u32 m0, s35, 50176
    s_nop 0
    buffer_load_dwordx4 v7, s[12:15], s36 offen lds
    s_add_u32 m0, s35, 115712
    s_add_u32 s37, s37, 13824
    buffer_load_dwordx4 v8, s[16:19], s37 offen lds
    s_add_u32 m0, s35, 51200
    s_add_u32 s36, s36, 10240
    buffer_load_dwordx4 v6, s[12:15], s36 offen lds
    s_add_u32 m0, s35, 116736
    s_add_u32 s37, s37, 13824
    buffer_load_dwordx4 v8, s[16:19], s37 offen lds
    s_add_u32 m0, s35, 52224
    s_nop 0
    buffer_load_dwordx4 v7, s[12:15], s36 offen lds
    s_add_u32 m0, s35, 117760
    s_add_u32 s37, s37, 13824
    buffer_load_dwordx4 v8, s[16:19], s37 offen lds
    s_add_u32 s32, s32, 1
    s_cmp_eq_u32 s32, 10
    s_cselect_b32 s32, 0, s32
    s_load_dwordx8 s[20:27], s[0:1], 56
    s_waitcnt lgkmcnt(0)
    s_mov_b64 s[6:7], s[26:27]
    s_mov_b64 s[86:87], s[52:53]
    s_mov_b64 s[40:41], s[54:55]
    s_mov_b64 s[42:43], s[56:57]
    s_mov_b64 s[46:47], s[62:63]
    s_mov_b64 s[80:81], s[64:65]
    s_mov_b64 s[82:83], s[20:21]
    s_mov_b64 s[84:85], s[22:23]
    s_load_dword s92, s[6:7], 0
    s_mov_b32 s64, s6
    s_mov_b32 s65, s7
    s_mov_b32 s66, 524288
    s_mov_b32 s67, 0x00020000
    s_waitcnt vmcnt(16)
    s_barrier
    s_lshl_b32 s36, s32, 7
    s_add_u32 s36, s36, s33
    s_mul_i32 s37, s32, 221184
    s_add_u32 s37, s37, s34
    s_add_u32 m0, s35, 0
    s_nop 0
    buffer_load_dwordx4 v6, s[12:15], s36 offen lds
    s_add_u32 m0, s35, 65536
    s_nop 0
    buffer_load_dwordx4 v8, s[16:19], s37 offen lds
    s_add_u32 m0, s35, 1024
    s_nop 0
    buffer_load_dwordx4 v7, s[12:15], s36 offen lds
    s_add_u32 m0, s35, 66560
    s_add_u32 s37, s37, 13824
    buffer_load_dwordx4 v8, s[16:19], s37 offen lds
    s_add_u32 m0, s35, 2048
    s_add_u32 s36, s36, 10240
    buffer_load_dwordx4 v6, s[12:15], s36 offen lds
    s_add_u32 m0, s35, 67584
    s_add_u32 s37, s37, 13824
    buffer_load_dwordx4 v8, s[16:19], s37 offen lds
    s_add_u32 m0, s35, 3072
    s_nop 0
    buffer_load_dwordx4 v7, s[12:15], s36 offen lds
    s_add_u32 m0, s35, 68608
    s_add_u32 s37, s37, 13824
    buffer_load_dwordx4 v8, s[16:19], s37 offen lds
    s_add_u32 s32, s32, 1
    s_cmp_eq_u32 s32, 10
    s_cselect_b32 s32, 0, s32
    s_waitcnt vmcnt(16)
    s_barrier
    s_lshl_b32 s36, s32, 7
    s_add_u32 s36, s36, s33
    s_mul_i32 s37, s32, 221184
    s_add_u32 s37, s37, s34
    s_add_u32 m0, s35, 16384
    s_nop 0
    buffer_load_dwordx4 v6, s[12:15], s36 offen lds
    s_add_u32 m0, s35, 81920
    s_nop 0
    buffer_load_dwordx4 v8, s[16:19], s37 offen lds
    s_add_u32 m0, s35, 17408
    s_nop 0
    buffer_load_dwordx4 v7, s[12:15], s36 offen lds
    s_add_u32 m0, s35, 82944
    s_add_u32 s37, s37, 13824
    buffer_load_dwordx4 v8, s[16:19], s37 offen lds
    s_add_u32 m0, s35, 18432
    s_add_u32 s36, s36, 10240
    buffer_load_dwordx4 v6, s[12:15], s36 offen lds
    s_add_u32 m0, s35, 83968
    s_add_u32 s37, s37, 13824
    buffer_load_dwordx4 v8, s[16:19], s37 offen lds
    s_add_u32 m0, s35, 19456
    s_nop 0
    buffer_load_dwordx4 v7, s[12:15], s36 offen lds
    s_add_u32 m0, s35, 84992
    s_add_u32 s37, s37, 13824
    buffer_load_dwordx4 v8, s[16:19], s37 offen lds
    s_add_u32 s32, s32, 1
    s_cmp_eq_u32 s32, 10
    s_cselect_b32 s32, 0, s32
    s_waitcnt vmcnt(16)
    s_barrier
    s_lshl_b32 s36, s32, 7
    s_add_u32 s36, s36, s33
    s_mul_i32 s37, s32, 221184
    s_add_u32 s37, s37, s34
    s_add_u32 m0, s35, 32768
    s_nop 0
    buffer_load_dwordx4 v6, s[12:15], s36 offen lds
    s_add_u32 m0, s35, 98304
    s_nop 0
    buffer_load_dwordx4 v8, s[16:19], s37 offen lds
    s_add_u32 m0, s35, 33792
    s_nop 0
    buffer_load_dwordx4 v7, s[12:15], s36 offen lds
    s_add_u32 m0, s35, 99328
    s_add_u32 s37, s37, 13824
    buffer_load_dwordx4 v8, s[16:19], s37 offen lds
    s_add_u32 m0, s35, 34816
    s_add_u32 s36, s36, 10240
    buffer_load_dwordx4 v6, s[12:15], s36 offen lds
    s_add_u32 m0, s35, 100352
    s_add_u32 s37, s37, 13824
    buffer_load_dwordx4 v8, s[16:19], s37 offen lds
    s_add_u32 m0, s35, 35840
    s_nop 0
    buffer_load_dwordx4 v7, s[12:15], s36 offen lds
    s_add_u32 m0, s35, 101376
    s_add_u32 s37, s37, 13824
    buffer_load_dwordx4 v8, s[16:19], s37 offen lds
    s_add_u32 s32, s32, 1
    s_cmp_eq_u32 s32, 10
    s_cselect_b32 s32, 0, s32
    s_waitcnt vmcnt(16)
    s_barrier
    s_lshl_b32 s36, s32, 7
    s_add_u32 s36, s36, s33
    s_mul_i32 s37, s32, 221184
    s_add_u32 s37, s37, s34
    s_add_u32 m0, s35, 49152
    s_nop 0
    buffer_load_dwordx4 v6, s[12:15], s36 offen lds
    s_add_u32 m0, s35, 114688
    s_nop 0
    buffer_load_dwordx4 v8, s[16:19], s37 offen lds
    s_add_u32 m0, s35, 50176
    s_nop 0
    buffer_load_dwordx4 v7, s[12:15], s36 offen lds
    s_add_u32 m0, s35, 115712
    s_add_u32 s37, s37, 13824
    buffer_load_dwordx4 v8, s[16:19], s37 offen lds
    s_add_u32 m0, s35, 51200
    s_add_u32 s36, s36, 10240
    buffer_load_dwordx4 v6, s[12:15], s36 offen lds
    s_add_u32 m0, s35, 116736
    s_add_u32 s37, s37, 13824
    buffer_load_dwordx4 v8, s[16:19], s37 offen lds
    s_add_u32 m0, s35, 52224
    s_nop 0
    buffer_load_dwordx4 v7, s[12:15], s36 offen lds
    s_add_u32 m0, s35, 117760
    s_add_u32 s37, s37, 13824
    buffer_load_dwordx4 v8, s[16:19], s37 offen lds
    s_add_u32 s32, s32, 1
    s_cmp_eq_u32 s32, 10
    s_cselect_b32 s32, 0, s32
    s_waitcnt vmcnt(16)
    s_barrier
    s_lshl_b32 s36, s32, 7
    s_add_u32 s36, s36, s33
    s_mul_i32 s37, s32, 221184
    s_add_u32 s37, s37, s34
    s_add_u32 m0, s35, 0
    s_nop 0
    buffer_load_dwordx4 v6, s[12:15], s36 offen lds
    s_add_u32 m0, s35, 65536
    s_nop 0
    buffer_load_dwordx4 v8, s[16:19], s37 offen lds
    s_add_u32 m0, s35, 1024
    s_nop 0
    buffer_load_dwordx4 v7, s[12:15], s36 offen lds
    s_add_u32 m0, s35, 66560
    s_add_u32 s37, s37, 13824
    buffer_load_dwordx4 v8, s[16:19], s37 offen lds
    s_add_u32 m0, s35, 2048
    s_add_u32 s36, s36, 10240
    buffer_load_dwordx4 v6, s[12:15], s36 offen lds
    s_add_u32 m0, s35, 67584
    s_add_u32 s37, s37, 13824
    buffer_load_dwordx4 v8, s[16:19], s37 offen lds
    s_add_u32 m0, s35, 3072
    s_nop 0
    buffer_load_dwordx4 v7, s[12:15], s36 offen lds
    s_add_u32 m0, s35, 68608
    s_add_u32 s37, s37, 13824
    buffer_load_dwordx4 v8, s[16:19], s37 offen lds
    s_add_u32 s32, s32, 1
    s_cmp_eq_u32 s32, 10
    s_cselect_b32 s32, 0, s32
    s_waitcnt lgkmcnt(0)
    s_add_u32 s92, s92, 1
    s_mul_i32 s93, s92, 0x9E3779B1
    s_xor_b32 s93, s93, 0x5bd1e995
    v_mov_b32 v10, s92
    ds_write_b32 v78, v10 offset:16
    s_cmp_lg_u32 s29, 0
    s_cbranch_scc1 k1_nop1
    s_mov_b64 exec, 15
    buffer_load_dwordx2 v[12:13], v11, s[64:67], s68 offen sc1
    s_mov_b64 exec, -1
k1_nop1:
    s_waitcnt vmcnt(16)
    s_barrier
    s_lshl_b32 s36, s32, 7
    s_add_u32 s36, s36, s33
    s_mul_i32 s37, s32, 221184
    s_add_u32 s37, s37, s34
    s_add_u32 m0, s35, 16384
    s_nop 0
    buffer_load_dwordx4 v6, s[12:15], s36 offen lds
    s_add_u32 m0, s35, 81920
    s_nop 0
    buffer_load_dwordx4 v8, s[16:19], s37 offen lds
    s_add_u32 m0, s35, 17408
    s_nop 0
    buffer_load_dwordx4 v7, s[12:15], s36 offen lds
    s_add_u32 m0, s35, 82944
    s_add_u32 s37, s37, 13824
    buffer_load_dwordx4 v8, s[16:19], s37 offen lds
    s_add_u32 m0, s35, 18432
    s_add_u32 s36, s36, 10240
    buffer_load_dwordx4 v6, s[12:15], s36 offen lds
    s_add_u32 m0, s35, 83968
    s_add_u32 s37, s37, 13824
    buffer_load_dwordx4 v8, s[16:19], s37 offen lds
    s_add_u32 m0, s35, 19456
    s_nop 0
    buffer_load_dwordx4 v7, s[12:15], s36 offen lds
    s_add_u32 m0, s35, 84992
    s_add_u32 s37, s37, 13824
    buffer_load_dwordx4 v8, s[16:19], s37 offen lds
    s_add_u32 s32, s32, 1
    s_cmp_eq_u32 s32, 10
    s_cselect_b32 s32, 0, s32
    s_waitcnt vmcnt(16)
    s_barrier
    s_add_u32 s52, s6, 15728640
    s_addc_u32 s53, s7, 0
    s_mov_b32 s54, 32768
    s_mov_b32 s55, 0x00020000
    s_cmp_lg_u32 s29, 0
    s_cbranch_scc1 k1_stw
    s_waitcnt vmcnt(8)
    s_mov_b32 s45, 0
    s_mov_b32 s44, 4
    s_mov_b64 exec, 15
k1_poll:
    v_cmp_ne_u64 vcc, s[92:93], v[12:13]
    s_nop 4
    s_cbranch_vccz k1_polled
    s_mov_b32 s44, 0
    s_add_u32 s45, s45, 1
    s_cmp_ge_u32 s45, 400
    s_cbranch_scc1 k1_pfail
    s_mov_b32 s44, 4
    buffer_load_dwordx2 v[12:13], v11, s[64:67], s68 offen sc1
    s_waitcnt vmcnt(0)
    s_branch k1_poll
k1_polled:
    s_mov_b64 exec, -1
    buffer_load_dwordx4 v[16:19], v24, s[52:55], s69 offen sc1
k1_pfail:
    s_mov_b64 exec, -1
    ds_write_b32 v78, v79 offset:12
    s_branch k1_nost
k1_stw:
    ds_read_b32 v10, v78 offset:12
    s_waitcnt lgkmcnt(0)
    v_readfirstlane_b32 s44, v10
    s_nop 1
    s_cmp_eq_u32 s44, 0
    s_cbranch_scc1 k1_stw
k1_nost:
    v_lshlrev_b32 v3, 3, v1
    v_lshlrev_b32 v2, 4, v1
    s_mov_b32 s20, s40
    s_mov_b32 s21, s41
    s_mov_b32 s22, 1314816
    s_mov_b32 s23, 0x00020000
    s_mov_b32 s24, s42
    s_mov_b32 s25, s43
    s_mov_b32 s26, 1314816
    s_mov_b32 s27, 0x00020000
    s_mul_i32 s38, s2, 171
    s_lshr_b32 s38, s38, 9
    s_mul_i32 s39, s38, 3
    s_sub_u32 s39, s2, s39
    s_add_u32 s38, s38, 224
    s_cmp_lt_u32 s29, 3
    s_cselect_b32 s38, s2, s38
    s_cselect_b32 s39, s29, s39
    s_lshr_b32 s50, s38, 5
    s_lshl_b32 s50, s50, 7
    s_and_b32 s51, s38, 31
    s_add_u32 s50, s50, s51
    s_mul_i32 s50, s50, 1284
    s_lshl_b32 s51, s39, 9
    s_add_u32 s50, s50, s51
    buffer_load_dwordx2 v[28:29], v3, s[20:23], s50 offen
    buffer_load_dwordx2 v[36:37], v3, s[24:27], s50 offen
    s_add_u32 s50, s50, 41088
    buffer_load_dwordx2 v[30:31], v3, s[20:23], s50 offen
    buffer_load_dwordx2 v[38:39], v3, s[24:27], s50 offen
    s_add_u32 s50, s50, 41088
    buffer_load_dwordx2 v[32:33], v3, s[20:23], s50 offen
    buffer_load_dwordx2 v[40:41], v3, s[24:27], s50 offen
    s_add_u32 s50, s50, 41088
    buffer_load_dwordx2 v[34:35], v3, s[20:23], s50 offen
    buffer_load_dwordx2 v[42:43], v3, s[24:27], s50 offen
    s_mov_b32 s56, s80
    s_mov_b32 s57, s81
    s_mov_b32 s58, 2211840
    s_mov_b32 s59, 0x00020000
    s_lshl_b32 s50, s2, 2
    s_add_u32 s50, s50, s29
    s_mul_i32 s50, s50, 2560
    buffer_load_dwordx4 v[60:63], v2, s[56:59], s50 offen
    buffer_load_dwordx4 v[64:67], v2, s[56:59], s50 offen offset:1024
    buffer_load_dwordx2 v[68:69], v3, s[56:59], s50 offen offset:2048
    s_add_u32 s60, s35, 131072
    v_lshl_add_u32 v72, v1, 6, s60
    v_lshl_add_u32 v73, v1, 4, s60
    s_lshl_b32 s61, s39, 8
    v_mov_b32 v4, 0x40000000
    v_add3_u32 v2, v1, s61, 0
    v_cmp_gt_u32 vcc, 648, v2
    v_lshlrev_b32 v2, 4, v2
    s_nop 0
    v_cndmask_b32 v74, v4, v2, vcc
    v_add3_u32 v2, v1, s61, 64
    v_cmp_gt_u32 vcc, 648, v2
    v_lshlrev_b32 v2, 4, v2
    s_nop 0
    v_cndmask_b32 v75, v4, v2, vcc
    v_add_u32 v2, 128, v1
    v_add_u32 v2, s61, v2
    v_cmp_gt_u32 vcc, 648, v2
    v_lshlrev_b32 v2, 4, v2
    s_nop 0
    v_cndmask_b32 v76, v4, v2, vcc
    v_add_u32 v2, 192, v1
    v_add_u32 v2, s61, v2
    v_cmp_gt_u32 vcc, 648, v2
    v_lshlrev_b32 v2, 4, v2
    s_nop 0
    v_cndmask_b32 v77, v4, v2, vcc
    s_mul_i32 s61, s38, 10368
    s_mov_b32 s62, 0x05040100
    s_mov_b32 s63, 0x07060302
    s_waitcnt vmcnt(11)
    s_barrier
    s_cmp_lg_u32 s29, 0
    s_cbranch_scc1 k1_lfin
    s_cmp_ge_u32 s44, 4
    s_cbranch_scc0 k1_slow
    s_waitcnt vmcnt(11)
    ds_write_b128 v25, v[16:19]
k1_lfin:
    s_cmp_ge_u32 s2, 82
    s_cbranch_scc1 k1_lnocc
    s_bfe_u32 s24, s2, 0x10003
    s_and_b32 s25, s2, 7
    s_mul_i32 s25, s25, 5
    s_lshr_b32 s26, s2, 4
    s_add_u32 s25, s25, s26
    s_and_b32 s26, s2, 1
    s_cmp_ge_u32 s2, 80
    s_cselect_b32 s24, s26, s24
    s_cselect_b32 s25, 40, s25
    v_and_b32 v106, 31, v0
    v_cvt_f32_u32 v100, v106
    v_bfe_u32 v106, v0, 5, 3
    v_lshlrev_b32 v106, 2, v106
    v_cvt_f32_u32 v101, v106
    s_cmp_eq_u32 s24, 0
    s_cselect_b32 s30, 0, 0x3c800000
    v_mul_f32 v104, 0x3d000000, v100
    v_mul_f32 v105, v104, v101
    v_and_b32 v107, 255, v0
    v_lshlrev_b32 v107, 4, v107
    v_add_u32 v107, 65536, v107
    v_add_f32 v102, s30, v104
    v_mul_f32 v103, v102, v101
    v_cos_f32 v128, v103
    v_sin_f32 v132, v103
    v_mul_f32 v116, 0x3d000000, v103
    v_sin_f32 v120, v116
    v_cos_f32 v116, v116
    v_cvt_pk_bf16_f32 v108, v128, v132
    v_cvt_pk_bf16_f32 v112, -v132, v128
    v_fmamk_f32 v125, v102, 0x3f800000, v103
    v_cos_f32 v129, v125
    v_sin_f32 v133, v125
    v_mul_f32 v117, 0x3d000000, v125
    v_sin_f32 v121, v117
    v_cos_f32 v117, v117
    v_cvt_pk_bf16_f32 v109, v129, v133
    v_cvt_pk_bf16_f32 v113, -v133, v129
    v_fmamk_f32 v126, v102, 0x40000000, v103
    v_cos_f32 v130, v126
    v_sin_f32 v134, v126
    v_mul_f32 v118, 0x3d000000, v126
    v_sin_f32 v122, v118
    v_cos_f32 v118, v118
    v_cvt_pk_bf16_f32 v110, v130, v134
    v_cvt_pk_bf16_f32 v114, -v134, v130
    v_fmamk_f32 v127, v102, 0x40400000, v103
    v_cos_f32 v131, v127
    v_sin_f32 v135, v127
    v_mul_f32 v119, 0x3d000000, v127
    v_sin_f32 v123, v119
    v_cos_f32 v119, v119
    v_cvt_pk_bf16_f32 v111, v131, v135
    v_cvt_pk_bf16_f32 v115, -v135, v131
    v_fma_f32 v103, v100, s30, v105
    v_cos_f32 v160, v103
    v_sin_f32 v164, v103
    v_mul_f32 v148, 0x3d000000, v103
    v_sin_f32 v152, v148
    v_cos_f32 v148, v148
    v_cvt_pk_bf16_f32 v140, v160, v164
    v_cvt_pk_bf16_f32 v144, -v164, v160
    v_fmamk_f32 v157, v104, 0x3f800000, v103
    v_cos_f32 v161, v157
    v_sin_f32 v165, v157
    v_mul_f32 v149, 0x3d000000, v157
    v_sin_f32 v153, v149
    v_cos_f32 v149, v149
    v_cvt_pk_bf16_f32 v141, v161, v165
    v_cvt_pk_bf16_f32 v145, -v165, v161
    v_fmamk_f32 v158, v104, 0x40000000, v103
    v_cos_f32 v162, v158
    v_sin_f32 v166, v158
    v_mul_f32 v150, 0x3d000000, v158
    v_sin_f32 v154, v150
    v_cos_f32 v150, v150
    v_cvt_pk_bf16_f32 v142, v162, v166
    v_cvt_pk_bf16_f32 v146, -v166, v162
    v_fmamk_f32 v159, v104, 0x40400000, v103
    v_cos_f32 v163, v159
    v_sin_f32 v167, v159
    v_mul_f32 v151, 0x3d000000, v159
    v_sin_f32 v155, v151
    v_cos_f32 v151, v151
    v_cvt_pk_bf16_f32 v143, v163, v167
    v_cvt_pk_bf16_f32 v147, -v167, v163
    v_cos_f32 v192, v105
    v_sin_f32 v196, v105
    s_nop 0
    v_cvt_pk_bf16_f32 v172, v192, v196
    v_cvt_pk_bf16_f32 v176, -v196, v192
    v_fmamk_f32 v189, v104, 0x3f800000, v105
    v_cos_f32 v193, v189
    v_sin_f32 v197, v189
    s_nop 0
    v_cvt_pk_bf16_f32 v173, v193, v197
    v_cvt_pk_bf16_f32 v177, -v197, v193
    v_fmamk_f32 v190, v104, 0x40000000, v105
    v_cos_f32 v194, v190
    v_sin_f32 v198, v190
    s_nop 0
    v_cvt_pk_bf16_f32 v174, v194, v198
    v_cvt_pk_bf16_f32 v178, -v198, v194
    v_fmamk_f32 v191, v104, 0x40400000, v105
    v_cos_f32 v195, v191
    v_sin_f32 v199, v191
    s_nop 0
    v_cvt_pk_bf16_f32 v175, v195, v199
    v_cvt_pk_bf16_f32 v179, -v199, v195
k1_lnocc:
    s_waitcnt lgkmcnt(0)
    s_barrier
    s_add_u32 s20, s6, 12582912
    s_addc_u32 s21, s7, 0
    s_mov_b32 s22, 2654336
    s_mov_b32 s23, 0x00020000
    s_waitcnt vmcnt(3)
    s_cmp_lt_u32 s2, 96
    s_cbranch_scc1 k1_lnw2
    s_lshr_b32 s10, s2, 5
    s_sub_u32 s10, s10, 3
    s_and_b32 s24, s2, 7
    s_lshl_b32 s24, s24, 2
    s_bfe_u32 s11, s2, 0x20003
    s_add_u32 s24, s24, s11
    s_lshr_b32 s25, s24, 4
    s_and_b32 s26, s24, 15
    v_and_b32 v1, 63, v0
    v_lshrrev_b32 v3, 4, v1
    v_lshlrev_b32 v2, 2, v3
    v_and_b32 v4, 15, v0
    v_xor_b32 v4, v4, v2
    v_mul_u32_u24 v5, 1280, v3
    v_lshl_add_u32 v5, v4, 4, v5
    s_sub_u32 s27, s3, 4
    s_mul_i32 s28, s25, 216
    s_add_u32 s28, s28, s27
    s_mul_i32 s28, s28, 5120
    s_lshl_b32 s29, s10, 8
    s_add_u32 s28, s28, s29
    s_lshl_b32 s29, s27, 10
    s_mov_b32 s12, s80
    s_mov_b32 s13, s81
    s_mov_b32 s14, 2211840
    s_mov_b32 s15, 0x00020000
k1_lnw2:
    v_perm_b32 v44, v36, v28, s62
    v_perm_b32 v45, v38, v30, s62
    v_perm_b32 v46, v40, v32, s62
    v_perm_b32 v47, v42, v34, s62
    ds_write_b128 v72, v[44:47] offset:0
    v_perm_b32 v48, v36, v28, s63
    v_perm_b32 v49, v38, v30, s63
    v_perm_b32 v50, v40, v32, s63
    v_perm_b32 v51, v42, v34, s63
    ds_write_b128 v72, v[48:51] offset:16
    v_perm_b32 v52, v37, v29, s62
    v_perm_b32 v53, v39, v31, s62
    v_perm_b32 v54, v41, v33, s62
    v_perm_b32 v55, v43, v35, s62
    ds_write_b128 v72, v[52:55] offset:32
    v_perm_b32 v56, v37, v29, s63
    v_perm_b32 v57, v39, v31, s63
    v_perm_b32 v58, v41, v33, s63
    v_perm_b32 v59, v43, v35, s63
    ds_write_b128 v72, v[56:59] offset:48
    s_waitcnt lgkmcnt(0)
    ds_read_b128 v[28:31], v73 offset:0
    ds_read_b128 v[32:35], v73 offset:1024
    ds_read_b128 v[36:39], v73 offset:2048
    ds_read_b128 v[40:43], v73 offset:3072
    s_waitcnt lgkmcnt(3)
    buffer_store_dwordx4 v[28:31], v74, s[20:23], s61 offen sc1
    s_waitcnt lgkmcnt(2)
    buffer_store_dwordx4 v[32:35], v75, s[20:23], s61 offen sc1
    s_waitcnt lgkmcnt(1)
    buffer_store_dwordx4 v[36:39], v76, s[20:23], s61 offen sc1
    s_waitcnt lgkmcnt(0)
    buffer_store_dwordx4 v[40:43], v77, s[20:23], s61 offen sc1
    s_cmp_ge_u32 s2, 82
    s_cbranch_scc1 k1_lnoc
    ds_write_b128 v107, v[108:111] offset:0
    ds_write_b128 v107, v[112:115] offset:4096
    ds_write_b128 v107, v[116:119] offset:8192
    ds_write_b128 v107, v[120:123] offset:12288
    ds_write_b128 v107, v[140:143] offset:16384
    ds_write_b128 v107, v[144:147] offset:20480
    ds_write_b128 v107, v[148:151] offset:24576
    ds_write_b128 v107, v[152:155] offset:28672
    ds_write_b128 v107, v[172:175] offset:32768
    ds_write_b128 v107, v[176:179] offset:36864
k1_lnoc:
    s_waitcnt vmcnt(0)
    s_mov_b64 exec, 1
    ds_add_rtn_u32 v10, v78, v79
    s_mov_b64 exec, -1
    s_lshl_b32 s58, s2, 6
    s_add_u32 s58, s58, 1024
    s_waitcnt lgkmcnt(0)
    v_readfirstlane_b32 s44, v10
    s_nop 1
    s_cmp_lg_u32 s44, 3
    s_cbranch_scc1 k1_lnofl
    s_mov_b32 s60, s6
    s_mov_b32 s61, s7
    s_mov_b32 s62, 524288
    s_mov_b32 s63, 0x00020000
    v_mov_b32 v246, s92
    v_mov_b32 v247, s93
    v_and_b32 v248, 63, v0
    v_lshlrev_b32 v248, 3, v248
    s_mov_b64 exec, 0xff
    buffer_store_dwordx2 v[246:247], v248, s[60:63], s58 offen sc1
    s_mov_b64 exec, -1
nofl1:
k1_lnofl:
    s_cmp_ge_u32 s2, 96
    s_cbranch_scc1 k2_lmain
    s_cmp_ge_u32 s2, 82
    s_cbranch_scc1 a_done2
    s_cmp_lg_u32 s3, 4
    s_cbranch_scc1 a_done2
    s_mov_b32 s60, s6
    s_mov_b32 s61, s7
    s_mov_b32 s62, 524288
    s_mov_b32 s63, 0x00020000
    s_mov_b32 s58, 15360
    v_and_b32 v10, 63, v0
    v_lshlrev_b32 v10, 6, v10
    s_mov_b32 s59, 0
    s_mov_b32 s56, 0xffffffff
    s_mov_b32 s57, 0x0
    s_ff1_i32_b64 s95, s[56:57]
    s_lshl_b64 exec, 1, s95
poll2a:
    buffer_load_dwordx2 v[8:9], v10, s[60:63], s58 offen sc1
    s_waitcnt vmcnt(0)
    v_cmp_ne_u64 vcc, s[92:93], v[8:9]
    s_nop 4
    s_cbranch_vccz poll2
    s_add_u32 s59, s59, 1
    s_cmp_ge_u32 s59, 0x8000
    s_cbranch_scc1 poll2d
    s_sleep 8
    s_branch poll2a
poll2:
    s_mov_b64 exec, s[56:57]
    buffer_load_dwordx2 v[8:9], v10, s[60:63], s58 offen sc1
    s_waitcnt vmcnt(0)
    v_cmp_ne_u64 s[56:57], s[92:93], v[8:9]
    s_nop 1
    s_mov_b64 vcc, s[56:57]
    s_cbranch_vccz poll2d
    s_add_u32 s59, s59, 1
    s_cmp_ge_u32 s59, 0x8000
    s_cbranch_scc1 poll2d
    s_sleep 2
    s_branch poll2
poll2d:
    s_mov_b64 exec, -1
    s_branch a_done2
k1_slow:
    v_mul_u32_u24 v2, 1280, v1
    s_mul_i32 s40, s10, 81920
    s_mov_b32 s41, 0
k1_slow_rows:
    v_mov_b32 v80, 0
    v_mov_b32 v81, 0
    s_mov_b32 s42, 0
k1_slow_k:
    s_add_u32 s43, s40, s42
    buffer_load_dwordx4 v[16:19], v2, s[12:15], s43 offen
    s_waitcnt vmcnt(0)
    v_lshlrev_b32 v82, 16, v16
    v_and_b32 v83, 0xffff0000, v16
    v_add_f32 v80, v80, v82
    v_fmac_f32 v81, v82, v82
    v_add_f32 v80, v80, v83
    v_fmac_f32 v81, v83, v83
    v_lshlrev_b32 v82, 16, v17
    v_and_b32 v83, 0xffff0000, v17
    v_add_f32 v80, v80, v82
    v_fmac_f32 v81, v82, v82
    v_add_f32 v80, v80, v83
    v_fmac_f32 v81, v83, v83
    v_lshlrev_b32 v82, 16, v18
    v_and_b32 v83, 0xffff0000, v18
    v_add_f32 v80, v80, v82
    v_fmac_f32 v81, v82, v82
    v_add_f32 v80, v80, v83
    v_fmac_f32 v81, v83, v83
    v_lshlrev_b32 v82, 16, v19
    v_and_b32 v83, 0xffff0000, v19
    v_add_f32 v80, v80, v82
    v_fmac_f32 v81, v82, v82
    v_add_f32 v80, v80, v83
    v_fmac_f32 v81, v83, v83
    s_add_u32 s42, s42, 16
    s_cmp_lt_u32 s42, 1280
    s_cbranch_scc1 k1_slow_k
    v_mul_f32 v80, 0x3acccccd, v80
    v_mul_f32 v81, 0x3acccccd, v81
    v_fma_f32 v81, -v80, v80, v81
    v_max_f32 v16, 0, v81
    v_cvt_pk_bf16_f32 v16, v16, v16
    v_and_b32 v16, 0xffff0000, v16
    v_add_f32 v16, 0x3727c5ac, v16
    v_cvt_pk_bf16_f32 v16, v16, v16
    v_and_b32 v16, 0xffff0000, v16
    v_sqrt_f32 v16, v16
    s_nop 0
    v_cvt_pk_bf16_f32 v16, v16, v16
    v_and_b32 v16, 0xffff0000, v16
    v_rcp_f32 v16, v16
    v_cvt_pk_bf16_f32 v80, v80, v80
    v_and_b32 v80, 0xffff0000, v80
    v_mul_f32 v17, v16, v80
    ds_write_b64 v25, v[16:17]
    v_add_u32 v25, 8, v25
    s_add_u32 s40, s40, 1310720
    s_add_u32 s41, s41, 1
    s_cmp_lt_u32 s41, 2
    s_waitcnt lgkmcnt(0)
    s_cbranch_scc1 k1_slow_rows
    s_branch k1_lfin
k1_comp:
    s_load_dwordx8 s[20:27], s[0:1], 56
    s_waitcnt lgkmcnt(0)
    s_mov_b64 s[6:7], s[26:27]
    s_mov_b64 s[86:87], s[52:53]
    s_mov_b64 s[40:41], s[54:55]
    s_mov_b64 s[42:43], s[56:57]
    s_mov_b64 s[46:47], s[62:63]
    s_mov_b64 s[80:81], s[64:65]
    s_mov_b64 s[82:83], s[20:21]
    s_mov_b64 s[84:85], s[22:23]
    s_mov_b32 s56, s46
    s_mov_b32 s57, s47
    s_mov_b32 s58, 3456
    s_mov_b32 s59, 0x00020000
    v_lshlrev_b32 v2, 2, v1
    s_lshl_b32 s31, s11, 8
    buffer_load_dword v6, v2, s[56:59], s31 offen
    v_lshlrev_b32 v8, 3, v1
    v_add_u32 v8, 147456, v8
    s_add_u32 s24, s6, 524288
    s_addc_u32 s25, s7, 0
    s_mov_b32 s26, 7077888
    s_mov_b32 s27, 0x00020000
    s_and_b32 s30, s3, 1
    s_lshr_b32 s29, s3, 1
    v_and_b32 v16, 31, v0
    v_bfe_u32 v17, v0, 5, 1
    v_bfe_u32 v2, v0, 1, 3
    v_xor_b32 v2, v2, v17
    v_lshlrev_b32 v2, 4, v2
    v_lshl_add_u32 v2, v16, 7, v2
    s_lshl_b32 s40, s29, 13
    v_add_u32 v10, s40, v2
    v_xor_b32 v11, 32, v10
    v_xor_b32 v12, 64, v10
    v_xor_b32 v13, 96, v10
    v_bfe_u32 v2, v0, 2, 2
    v_lshl_add_u32 v3, v17, 3, v2
    v_lshlrev_b32 v3, 8, v3
    v_bfe_u32 v4, v0, 4, 1
    v_lshl_add_u32 v3, v4, 5, v3
    v_and_b32 v4, 3, v0
    v_lshl_add_u32 v3, v4, 3, v3
    v_lshl_add_u32 v3, v2, 6, v3
    s_lshl_b32 s41, s30, 1
    s_or_b32 s41, s41, s29
    s_lshl_b32 s41, s41, 6
    s_or_b32 s41, s41, 65536
    v_xor_b32 v14, s41, v3
    v_xor_b32 v15, 64, v14
    v_lshrrev_b32 v2, 2, v0
    v_xor_b32 v2, v2, v0
    v_and_b32 v2, 4, v2
    v_cmp_eq_u32 vcc, 0, v2
    v_mov_b32 v2, 0x3f803f80
    s_nop 0
    v_cndmask_b32 v20, 0, v2, vcc
    v_cndmask_b32 v21, 0, v2, vcc
    v_cndmask_b32 v22, 0, v2, vcc
    v_cndmask_b32 v23, 0, v2, vcc
    v_and_b32 v2, 11, v0
    v_cmp_eq_u32 s[98:99], 0, v2
    s_lshl_b32 s40, s30, 8
    s_lshl_b32 s41, s29, 7
    s_add_u32 s40, s40, s41
    s_add_u32 s40, s40, 147456
    v_and_b32 v3, 48, v0
    v_bfe_u32 v2, v0, 2, 1
    v_lshl_add_u32 v3, v2, 6, v3
    v_add_u32 v24, s40, v3
    v_lshl_add_u32 v26, v17, 4, s40
    v_xor_b32 v27, 128, v26
    s_lshl_b32 s40, s29, 9
    s_add_u32 s40, s40, 148480
    v_bfe_u32 v2, v0, 3, 2
    v_lshl_add_u32 v28, v2, 6, s40
    v_and_b32 v2, 3, v0
    v_lshl_add_u32 v28, v2, 4, v28
    v_and_b32 v2, 4, v0
    v_lshl_add_u32 v28, v2, 1, v28
    v_mov_b32 v30, 0xc0135761
    v_mov_b32 v32, 0xbdd2d3e8
    v_mov_b32 v34, 1.0
    v_lshlrev_b32 v29, 4, v1
    s_lshl_b32 s40, s10, 1
    s_add_u32 s40, s40, s29
    s_mul_i32 s40, s40, 216
    s_lshl_b32 s41, s11, 3
    s_add_u32 s40, s40, s41
    s_lshl_b32 s41, s30, 2
    s_add_u32 s40, s40, s41
    s_lshl_b32 s40, s40, 10
    s_lshl_b32 s41, s29, 11
    s_add_u32 s44, s40, s41
    s_xor_b32 s41, s41, 2048
    s_add_u32 s46, s40, s41
    s_add_u32 s45, s44, 110592
    s_add_u32 s47, s46, 110592
    s_cmp_eq_u32 s11, 13
    s_cselect_b32 s40, s30, 0
    s_cmp_eq_u32 s40, 0
    s_cbranch_scc1 k1_live
    s_barrier
    s_barrier
    s_barrier
    s_barrier
    s_barrier
    s_barrier
    s_barrier
    s_barrier
    s_barrier
    v_mov_b32 v3, 150544
    ds_read_b32 v2, v3
    s_waitcnt vmcnt(0)
    s_branch k1_dead
k1_live:
    s_barrier
    ds_read_b128 v[104:107], v10 offset:0
    ds_read_b64_tr_b16 v[136:137], v14 offset:0
    ds_read_b64_tr_b16 v[138:139], v14 offset:1024
    ds_read_b128 v[108:111], v10 offset:4096
    ds_read_b64_tr_b16 v[140:141], v15 offset:0
    ds_read_b64_tr_b16 v[142:143], v15 offset:1024
    ds_read_b128 v[112:115], v11 offset:0
    ds_read_b64_tr_b16 v[144:145], v14 offset:4096
    ds_read_b64_tr_b16 v[146:147], v14 offset:5120
    ds_read_b128 v[116:119], v11 offset:4096
    ds_read_b64_tr_b16 v[148:149], v15 offset:4096
    ds_read_b64_tr_b16 v[150:151], v15 offset:5120
    s_waitcnt lgkmcnt(6)
    v_mfma_f32_32x32x16_bf16 v[36:51], v[136:139], v[104:107], 0
    ds_read_b128 v[120:123], v12 offset:0
    ds_read_b64_tr_b16 v[152:153], v14 offset:8192
    v_mfma_f32_32x32x16_bf16 v[52:67], v[136:139], v[108:111], 0
    ds_read_b64_tr_b16 v[154:155], v14 offset:9216
    ds_read_b128 v[124:127], v12 offset:4096
    v_mfma_f32_32x32x16_bf16 v[84:99], v[140:143], v[108:111], 0
    ds_read_b64_tr_b16 v[156:157], v15 offset:8192
    ds_read_b64_tr_b16 v[158:159], v15 offset:9216
    v_mfma_f32_32x32x16_bf16 v[68:83], v[140:143], v[104:107], 0
    v_mfma_f32_16x16x32_bf16 v[100:103], v[136:139], v[20:23], 0
    s_waitcnt lgkmcnt(6)
    v_mfma_f32_32x32x16_bf16 v[36:51], v[144:147], v[112:115], v[36:51]
    ds_read_b128 v[128:131], v13 offset:0
    ds_read_b64_tr_b16 v[160:161], v14 offset:12288
    v_mfma_f32_32x32x16_bf16 v[52:67], v[144:147], v[116:119], v[52:67]
    ds_read_b64_tr_b16 v[162:163], v14 offset:13312
    ds_read_b128 v[132:135], v13 offset:4096
    v_mfma_f32_32x32x16_bf16 v[84:99], v[148:151], v[116:119], v[84:99]
    ds_read_b64_tr_b16 v[164:165], v15 offset:12288
    ds_read_b64_tr_b16 v[166:167], v15 offset:13312
    v_mfma_f32_32x32x16_bf16 v[68:83], v[148:151], v[112:115], v[68:83]
    v_mfma_f32_16x16x32_bf16 v[100:103], v[144:147], v[20:23], v[100:103]
    s_waitcnt lgkmcnt(6)
    v_mfma_f32_32x32x16_bf16 v[36:51], v[152:155], v[120:123], v[36:51]
    s_waitcnt lgkmcnt(0)
    s_barrier
    ds_read_b128 v[104:107], v10 offset:16384
    ds_read_b64_tr_b16 v[136:137], v14 offset:16384
    v_mfma_f32_32x32x16_bf16 v[52:67], v[152:155], v[124:127], v[52:67]
    ds_read_b64_tr_b16 v[138:139], v14 offset:17408
    ds_read_b128 v[108:111], v10 offset:20480
    v_mfma_f32_32x32x16_bf16 v[84:99], v[156:159], v[124:127], v[84:99]
    ds_read_b64_tr_b16 v[140:141], v15 offset:16384
    ds_read_b64_tr_b16 v[142:143], v15 offset:17408
    v_mfma_f32_32x32x16_bf16 v[68:83], v[156:159], v[120:123], v[68:83]
    v_mfma_f32_16x16x32_bf16 v[100:103], v[152:155], v[20:23], v[100:103]
    s_waitcnt lgkmcnt(6)
    v_mfma_f32_32x32x16_bf16 v[36:51], v[160:163], v[128:131], v[36:51]
    ds_read_b128 v[112:115], v11 offset:16384
    ds_read_b64_tr_b16 v[144:145], v14 offset:20480
    v_mfma_f32_32x32x16_bf16 v[52:67], v[160:163], v[132:135], v[52:67]
    ds_read_b64_tr_b16 v[146:147], v14 offset:21504
    ds_read_b128 v[116:119], v11 offset:20480
    v_mfma_f32_32x32x16_bf16 v[84:99], v[164:167], v[132:135], v[84:99]
    ds_read_b64_tr_b16 v[148:149], v15 offset:20480
    ds_read_b64_tr_b16 v[150:151], v15 offset:21504
    v_mfma_f32_32x32x16_bf16 v[68:83], v[164:167], v[128:131], v[68:83]
    v_mfma_f32_16x16x32_bf16 v[100:103], v[160:163], v[20:23], v[100:103]
    s_waitcnt lgkmcnt(6)
    v_mfma_f32_32x32x16_bf16 v[36:51], v[136:139], v[104:107], v[36:51]
    ds_read_b128 v[120:123], v12 offset:16384
    ds_read_b64_tr_b16 v[152:153], v14 offset:24576
    v_mfma_f32_32x32x16_bf16 v[52:67], v[136:139], v[108:111], v[52:67]
    ds_read_b64_tr_b16 v[154:155], v14 offset:25600
    ds_read_b128 v[124:127], v12 offset:20480
    v_mfma_f32_32x32x16_bf16 v[84:99], v[140:143], v[108:111], v[84:99]
    ds_read_b64_tr_b16 v[156:157], v15 offset:24576
    ds_read_b64_tr_b16 v[158:159], v15 offset:25600
    v_mfma_f32_32x32x16_bf16 v[68:83], v[140:143], v[104:107], v[68:83]
    v_mfma_f32_16x16x32_bf16 v[100:103], v[136:139], v[20:23], v[100:103]
    s_waitcnt lgkmcnt(6)
    v_mfma_f32_32x32x16_bf16 v[36:51], v[144:147], v[112:115], v[36:51]
    ds_read_b128 v[128:131], v13 offset:16384
    ds_read_b64_tr_b16 v[160:161], v14 offset:28672
    v_mfma_f32_32x32x16_bf16 v[52:67], v[144:147], v[116:119], v[52:67]
    ds_read_b64_tr_b16 v[162:163], v14 offset:29696
    ds_read_b128 v[132:135], v13 offset:20480
    v_mfma_f32_32x32x16_bf16 v[84:99], v[148:151], v[116:119], v[84:99]
    ds_read_b64_tr_b16 v[164:165], v15 offset:28672
    ds_read_b64_tr_b16 v[166:167], v15 offset:29696
    v_mfma_f32_32x32x16_bf16 v[68:83], v[148:151], v[112:115], v[68:83]
    v_mfma_f32_16x16x32_bf16 v[100:103], v[144:147], v[20:23], v[100:103]
    s_waitcnt vmcnt(0)
    v_and_b32 v7, 0xffff0000, v6
    v_lshlrev_b32 v6, 16, v6
    ds_write_b64 v8, v[6:7] offset:512
    s_waitcnt lgkmcnt(6)
    v_mfma_f32_32x32x16_bf16 v[36:51], v[152:155], v[120:123], v[36:51]
    s_waitcnt lgkmcnt(0)
    s_barrier
    ds_read_b128 v[104:107], v10 offset:32768
    ds_read_b64_tr_b16 v[136:137], v14 offset:32768
    v_mfma_f32_32x32x16_bf16 v[52:67], v[152:155], v[124:127], v[52:67]
    ds_read_b64_tr_b16 v[138:139], v14 offset:33792
    ds_read_b128 v[108:111], v10 offset:36864
    v_mfma_f32_32x32x16_bf16 v[84:99], v[156:159], v[124:127], v[84:99]
    ds_read_b64_tr_b16 v[140:141], v15 offset:32768
    ds_read_b64_tr_b16 v[142:143], v15 offset:33792
    v_mfma_f32_32x32x16_bf16 v[68:83], v[156:159], v[120:123], v[68:83]
    v_mfma_f32_16x16x32_bf16 v[100:103], v[152:155], v[20:23], v[100:103]
    s_waitcnt lgkmcnt(6)
    v_mfma_f32_32x32x16_bf16 v[36:51], v[160:163], v[128:131], v[36:51]
    ds_read_b128 v[112:115], v11 offset:32768
    ds_read_b64_tr_b16 v[144:145], v14 offset:36864
    v_mfma_f32_32x32x16_bf16 v[52:67], v[160:163], v[132:135], v[52:67]
    ds_read_b64_tr_b16 v[146:147], v14 offset:37888
    ds_read_b128 v[116:119], v11 offset:36864
    v_mfma_f32_32x32x16_bf16 v[84:99], v[164:167], v[132:135], v[84:99]
    ds_read_b64_tr_b16 v[148:149], v15 offset:36864
    ds_read_b64_tr_b16 v[150:151], v15 offset:37888
    v_mfma_f32_32x32x16_bf16 v[68:83], v[164:167], v[128:131], v[68:83]
    v_mfma_f32_16x16x32_bf16 v[100:103], v[160:163], v[20:23], v[100:103]
    s_waitcnt lgkmcnt(6)
    v_mfma_f32_32x32x16_bf16 v[36:51], v[136:139], v[104:107], v[36:51]
    ds_read_b128 v[120:123], v12 offset:32768
    ds_read_b64_tr_b16 v[152:153], v14 offset:40960
    v_mfma_f32_32x32x16_bf16 v[52:67], v[136:139], v[108:111], v[52:67]
    ds_read_b64_tr_b16 v[154:155], v14 offset:41984
    ds_read_b128 v[124:127], v12 offset:36864
    v_mfma_f32_32x32x16_bf16 v[84:99], v[140:143], v[108:111], v[84:99]
    ds_read_b64_tr_b16 v[156:157], v15 offset:40960
    ds_read_b64_tr_b16 v[158:159], v15 offset:41984
    v_mfma_f32_32x32x16_bf16 v[68:83], v[140:143], v[104:107], v[68:83]
    v_mfma_f32_16x16x32_bf16 v[100:103], v[136:139], v[20:23], v[100:103]
    s_waitcnt lgkmcnt(6)
    v_mfma_f32_32x32x16_bf16 v[36:51], v[144:147], v[112:115], v[36:51]
    ds_read_b128 v[128:131], v13 offset:32768
    ds_read_b64_tr_b16 v[160:161], v14 offset:45056
    v_mfma_f32_32x32x16_bf16 v[52:67], v[144:147], v[116:119], v[52:67]
    ds_read_b64_tr_b16 v[162:163], v14 offset:46080
    ds_read_b128 v[132:135], v13 offset:36864
    v_mfma_f32_32x32x16_bf16 v[84:99], v[148:151], v[116:119], v[84:99]
    ds_read_b64_tr_b16 v[164:165], v15 offset:45056
    ds_read_b64_tr_b16 v[166:167], v15 offset:46080
    v_mfma_f32_32x32x16_bf16 v[68:83], v[148:151], v[112:115], v[68:83]
    v_mfma_f32_16x16x32_bf16 v[100:103], v[144:147], v[20:23], v[100:103]
    s_waitcnt lgkmcnt(6)
    v_mfma_f32_32x32x16_bf16 v[36:51], v[152:155], v[120:123], v[36:51]
    s_waitcnt lgkmcnt(0)
    s_barrier
    ds_read_b128 v[104:107], v10 offset:49152
    ds_read_b64_tr_b16 v[136:137], v14 offset:49152
    v_mfma_f32_32x32x16_bf16 v[52:67], v[152:155], v[124:127], v[52:67]
    ds_read_b64_tr_b16 v[138:139], v14 offset:50176
    ds_read_b128 v[108:111], v10 offset:53248
    v_mfma_f32_32x32x16_bf16 v[84:99], v[156:159], v[124:127], v[84:99]
    ds_read_b64_tr_b16 v[140:141], v15 offset:49152
    ds_read_b64_tr_b16 v[142:143], v15 offset:50176
    v_mfma_f32_32x32x16_bf16 v[68:83], v[156:159], v[120:123], v[68:83]
    v_mfma_f32_16x16x32_bf16 v[100:103], v[152:155], v[20:23], v[100:103]
    s_waitcnt lgkmcnt(6)
    v_mfma_f32_32x32x16_bf16 v[36:51], v[160:163], v[128:131], v[36:51]
    ds_read_b128 v[112:115], v11 offset:49152
    ds_read_b64_tr_b16 v[144:145], v14 offset:53248
    v_mfma_f32_32x32x16_bf16 v[52:67], v[160:163], v[132:135], v[52:67]
    ds_read_b64_tr_b16 v[146:147], v14 offset:54272
    ds_read_b128 v[116:119], v11 offset:53248
    v_mfma_f32_32x32x16_bf16 v[84:99], v[164:167], v[132:135], v[84:99]
    ds_read_b64_tr_b16 v[148:149], v15 offset:53248
    ds_read_b64_tr_b16 v[150:151], v15 offset:54272
    v_mfma_f32_32x32x16_bf16 v[68:83], v[164:167], v[128:131], v[68:83]
    v_mfma_f32_16x16x32_bf16 v[100:103], v[160:163], v[20:23], v[100:103]
    s_waitcnt lgkmcnt(6)
    v_mfma_f32_32x32x16_bf16 v[36:51], v[136:139], v[104:107], v[36:51]
    ds_read_b128 v[120:123], v12 offset:49152
    ds_read_b64_tr_b16 v[152:153], v14 offset:57344
    v_mfma_f32_32x32x16_bf16 v[52:67], v[136:139], v[108:111], v[52:67]
    ds_read_b64_tr_b16 v[154:155], v14 offset:58368
    ds_read_b128 v[124:127], v12 offset:53248
    v_mfma_f32_32x32x16_bf16 v[84:99], v[140:143], v[108:111], v[84:99]
    ds_read_b64_tr_b16 v[156:157], v15 offset:57344
    ds_read_b64_tr_b16 v[158:159], v15 offset:58368
    v_mfma_f32_32x32x16_bf16 v[68:83], v[140:143], v[104:107], v[68:83]
    v_mfma_f32_16x16x32_bf16 v[100:103], v[136:139], v[20:23], v[100:103]
    s_waitcnt lgkmcnt(6)
    v_mfma_f32_32x32x16_bf16 v[36:51], v[144:147], v[112:115], v[36:51]
    ds_read_b128 v[128:131], v13 offset:49152
    ds_read_b64_tr_b16 v[160:161], v14 offset:61440
    v_mfma_f32_32x32x16_bf16 v[52:67], v[144:147], v[116:119], v[52:67]
    ds_read_b64_tr_b16 v[162:163], v14 offset:62464
    ds_read_b128 v[132:135], v13 offset:53248
    v_mfma_f32_32x32x16_bf16 v[84:99], v[148:151], v[116:119], v[84:99]
    ds_read_b64_tr_b16 v[164:165], v15 offset:61440
    ds_read_b64_tr_b16 v[166:167], v15 offset:62464
    v_mfma_f32_32x32x16_bf16 v[68:83], v[148:151], v[112:115], v[68:83]
    v_mfma_f32_16x16x32_bf16 v[100:103], v[144:147], v[20:23], v[100:103]
    s_waitcnt lgkmcnt(6)
    v_mfma_f32_32x32x16_bf16 v[36:51], v[152:155], v[120:123], v[36:51]
    s_waitcnt lgkmcnt(0)
    s_barrier
    ds_read_b128 v[104:107], v10 offset:0
    ds_read_b64_tr_b16 v[136:137], v14 offset:0
    v_mfma_f32_32x32x16_bf16 v[52:67], v[152:155], v[124:127], v[52:67]
    ds_read_b64_tr_b16 v[138:139], v14 offset:1024
    ds_read_b128 v[108:111], v10 offset:4096
    v_mfma_f32_32x32x16_bf16 v[84:99], v[156:159], v[124:127], v[84:99]
    ds_read_b64_tr_b16 v[140:141], v15 offset:0
    ds_read_b64_tr_b16 v[142:143], v15 offset:1024
    v_mfma_f32_32x32x16_bf16 v[68:83], v[156:159], v[120:123], v[68:83]
    v_mfma_f32_16x16x32_bf16 v[100:103], v[152:155], v[20:23], v[100:103]
    s_waitcnt lgkmcnt(6)
    v_mfma_f32_32x32x16_bf16 v[36:51], v[160:163], v[128:131], v[36:51]
    ds_read_b128 v[112:115], v11 offset:0
    ds_read_b64_tr_b16 v[144:145], v14 offset:4096
    v_mfma_f32_32x32x16_bf16 v[52:67], v[160:163], v[132:135], v[52:67]
    ds_read_b64_tr_b16 v[146:147], v14 offset:5120
    ds_read_b128 v[116:119], v11 offset:4096
    v_mfma_f32_32x32x16_bf16 v[84:99], v[164:167], v[132:135], v[84:99]
    ds_read_b64_tr_b16 v[148:149], v15 offset:4096
    ds_read_b64_tr_b16 v[150:151], v15 offset:5120
    v_mfma_f32_32x32x16_bf16 v[68:83], v[164:167], v[128:131], v[68:83]
    v_mfma_f32_16x16x32_bf16 v[100:103], v[160:163], v[20:23], v[100:103]
    s_waitcnt lgkmcnt(6)
    v_mfma_f32_32x32x16_bf16 v[36:51], v[136:139], v[104:107], v[36:51]
    ds_read_b128 v[120:123], v12 offset:0
    ds_read_b64_tr_b16 v[152:153], v14 offset:8192
    v_mfma_f32_32x32x16_bf16 v[52:67], v[136:139], v[108:111], v[52:67]
    ds_read_b64_tr_b16 v[154:155], v14 offset:9216
    ds_read_b128 v[124:127], v12 offset:4096
    v_mfma_f32_32x32x16_bf16 v[84:99], v[140:143], v[108:111], v[84:99]
    ds_read_b64_tr_b16 v[156:157], v15 offset:8192
    ds_read_b64_tr_b16 v[158:159], v15 offset:9216
    v_mfma_f32_32x32x16_bf16 v[68:83], v[140:143], v[104:107], v[68:83]
    v_mfma_f32_16x16x32_bf16 v[100:103], v[136:139], v[20:23], v[100:103]
    s_waitcnt lgkmcnt(6)
    v_mfma_f32_32x32x16_bf16 v[36:51], v[144:147], v[112:115], v[36:51]
    ds_read_b128 v[128:131], v13 offset:0
    ds_read_b64_tr_b16 v[160:161], v14 offset:12288
    v_mfma_f32_32x32x16_bf16 v[52:67], v[144:147], v[116:119], v[52:67]
    ds_read_b64_tr_b16 v[162:163], v14 offset:13312
    ds_read_b128 v[132:135], v13 offset:4096
    v_mfma_f32_32x32x16_bf16 v[84:99], v[148:151], v[116:119], v[84:99]
    ds_read_b64_tr_b16 v[164:165], v15 offset:12288
    ds_read_b64_tr_b16 v[166:167], v15 offset:13312
    v_mfma_f32_32x32x16_bf16 v[68:83], v[148:151], v[112:115], v[68:83]
    v_mfma_f32_16x16x32_bf16 v[100:103], v[144:147], v[20:23], v[100:103]
    s_waitcnt lgkmcnt(6)
    v_mfma_f32_32x32x16_bf16 v[36:51], v[152:155], v[120:123], v[36:51]
    s_waitcnt lgkmcnt(0)
    s_barrier
    ds_read_b128 v[104:107], v10 offset:16384
    ds_read_b64_tr_b16 v[136:137], v14 offset:16384
    v_mfma_f32_32x32x16_bf16 v[52:67], v[152:155], v[124:127], v[52:67]
    ds_read_b64_tr_b16 v[138:139], v14 offset:17408
    ds_read_b128 v[108:111], v10 offset:20480
    v_mfma_f32_32x32x16_bf16 v[84:99], v[156:159], v[124:127], v[84:99]
    ds_read_b64_tr_b16 v[140:141], v15 offset:16384
    ds_read_b64_tr_b16 v[142:143], v15 offset:17408
    v_mfma_f32_32x32x16_bf16 v[68:83], v[156:159], v[120:123], v[68:83]
    v_mfma_f32_16x16x32_bf16 v[100:103], v[152:155], v[20:23], v[100:103]
    s_waitcnt lgkmcnt(6)
    v_mfma_f32_32x32x16_bf16 v[36:51], v[160:163], v[128:131], v[36:51]
    ds_read_b128 v[112:115], v11 offset:16384
    ds_read_b64_tr_b16 v[144:145], v14 offset:20480
    v_mfma_f32_32x32x16_bf16 v[52:67], v[160:163], v[132:135], v[52:67]
    ds_read_b64_tr_b16 v[146:147], v14 offset:21504
    ds_read_b128 v[116:119], v11 offset:20480
    v_mfma_f32_32x32x16_bf16 v[84:99], v[164:167], v[132:135], v[84:99]
    ds_read_b64_tr_b16 v[148:149], v15 offset:20480
    ds_read_b64_tr_b16 v[150:151], v15 offset:21504
    v_mfma_f32_32x32x16_bf16 v[68:83], v[164:167], v[128:131], v[68:83]
    v_mfma_f32_16x16x32_bf16 v[100:103], v[160:163], v[20:23], v[100:103]
    s_waitcnt lgkmcnt(6)
    v_mfma_f32_32x32x16_bf16 v[36:51], v[136:139], v[104:107], v[36:51]
    ds_read_b128 v[120:123], v12 offset:16384
    ds_read_b64_tr_b16 v[152:153], v14 offset:24576
    v_mfma_f32_32x32x16_bf16 v[52:67], v[136:139], v[108:111], v[52:67]
    ds_read_b64_tr_b16 v[154:155], v14 offset:25600
    ds_read_b128 v[124:127], v12 offset:20480
    v_mfma_f32_32x32x16_bf16 v[84:99], v[140:143], v[108:111], v[84:99]
    ds_read_b64_tr_b16 v[156:157], v15 offset:24576
    ds_read_b64_tr_b16 v[158:159], v15 offset:25600
    v_mfma_f32_32x32x16_bf16 v[68:83], v[140:143], v[104:107], v[68:83]
    v_mfma_f32_16x16x32_bf16 v[100:103], v[136:139], v[20:23], v[100:103]
    s_waitcnt lgkmcnt(6)
    v_mfma_f32_32x32x16_bf16 v[36:51], v[144:147], v[112:115], v[36:51]
    ds_read_b128 v[128:131], v13 offset:16384
    ds_read_b64_tr_b16 v[160:161], v14 offset:28672
    v_mfma_f32_32x32x16_bf16 v[52:67], v[144:147], v[116:119], v[52:67]
    ds_read_b64_tr_b16 v[162:163], v14 offset:29696
    ds_read_b128 v[132:135], v13 offset:20480
    v_mfma_f32_32x32x16_bf16 v[84:99], v[148:151], v[116:119], v[84:99]
    ds_read_b64_tr_b16 v[164:165], v15 offset:28672
    ds_read_b64_tr_b16 v[166:167], v15 offset:29696
    v_mfma_f32_32x32x16_bf16 v[68:83], v[148:151], v[112:115], v[68:83]
    v_mfma_f32_16x16x32_bf16 v[100:103], v[144:147], v[20:23], v[100:103]
    s_waitcnt lgkmcnt(6)
    v_mfma_f32_32x32x16_bf16 v[36:51], v[152:155], v[120:123], v[36:51]
    s_waitcnt lgkmcnt(0)
    s_barrier
    ds_read_b128 v[104:107], v10 offset:32768
    ds_read_b64_tr_b16 v[136:137], v14 offset:32768
    v_mfma_f32_32x32x16_bf16 v[52:67], v[152:155], v[124:127], v[52:67]
    ds_read_b64_tr_b16 v[138:139], v14 offset:33792
    ds_read_b128 v[108:111], v10 offset:36864
    v_mfma_f32_32x32x16_bf16 v[84:99], v[156:159], v[124:127], v[84:99]
    ds_read_b64_tr_b16 v[140:141], v15 offset:32768
    ds_read_b64_tr_b16 v[142:143], v15 offset:33792
    v_mfma_f32_32x32x16_bf16 v[68:83], v[156:159], v[120:123], v[68:83]
    v_mfma_f32_16x16x32_bf16 v[100:103], v[152:155], v[20:23], v[100:103]
    s_waitcnt lgkmcnt(6)
    v_mfma_f32_32x32x16_bf16 v[36:51], v[160:163], v[128:131], v[36:51]
    ds_read_b128 v[112:115], v11 offset:32768
    ds_read_b64_tr_b16 v[144:145], v14 offset:36864
    v_mfma_f32_32x32x16_bf16 v[52:67], v[160:163], v[132:135], v[52:67]
    ds_read_b64_tr_b16 v[146:147], v14 offset:37888
    ds_read_b128 v[116:119], v11 offset:36864
    v_mfma_f32_32x32x16_bf16 v[84:99], v[164:167], v[132:135], v[84:99]
    ds_read_b64_tr_b16 v[148:149], v15 offset:36864
    ds_read_b64_tr_b16 v[150:151], v15 offset:37888
    v_mfma_f32_32x32x16_bf16 v[68:83], v[164:167], v[128:131], v[68:83]
    v_mfma_f32_16x16x32_bf16 v[100:103], v[160:163], v[20:23], v[100:103]
    s_waitcnt lgkmcnt(6)
    v_mfma_f32_32x32x16_bf16 v[36:51], v[136:139], v[104:107], v[36:51]
    ds_read_b128 v[120:123], v12 offset:32768
    ds_read_b64_tr_b16 v[152:153], v14 offset:40960
    v_mfma_f32_32x32x16_bf16 v[52:67], v[136:139], v[108:111], v[52:67]
    ds_read_b64_tr_b16 v[154:155], v14 offset:41984
    ds_read_b128 v[124:127], v12 offset:36864
    v_mfma_f32_32x32x16_bf16 v[84:99], v[140:143], v[108:111], v[84:99]
    ds_read_b64_tr_b16 v[156:157], v15 offset:40960
    ds_read_b64_tr_b16 v[158:159], v15 offset:41984
    v_mfma_f32_32x32x16_bf16 v[68:83], v[140:143], v[104:107], v[68:83]
    v_mfma_f32_16x16x32_bf16 v[100:103], v[136:139], v[20:23], v[100:103]
    s_waitcnt lgkmcnt(6)
    v_mfma_f32_32x32x16_bf16 v[36:51], v[144:147], v[112:115], v[36:51]
    ds_read_b128 v[128:131], v13 offset:32768
    ds_read_b64_tr_b16 v[160:161], v14 offset:45056
    v_mfma_f32_32x32x16_bf16 v[52:67], v[144:147], v[116:119], v[52:67]
    ds_read_b64_tr_b16 v[162:163], v14 offset:46080
    ds_read_b128 v[132:135], v13 offset:36864
    v_mfma_f32_32x32x16_bf16 v[84:99], v[148:151], v[116:119], v[84:99]
    ds_read_b64_tr_b16 v[164:165], v15 offset:45056
    ds_read_b64_tr_b16 v[166:167], v15 offset:46080
    v_mfma_f32_32x32x16_bf16 v[68:83], v[148:151], v[112:115], v[68:83]
    v_mfma_f32_16x16x32_bf16 v[100:103], v[144:147], v[20:23], v[100:103]
    s_waitcnt lgkmcnt(6)
    v_mfma_f32_32x32x16_bf16 v[36:51], v[152:155], v[120:123], v[36:51]
    s_waitcnt lgkmcnt(0)
    s_barrier
    ds_read_b128 v[104:107], v10 offset:49152
    ds_read_b64_tr_b16 v[136:137], v14 offset:49152
    v_mfma_f32_32x32x16_bf16 v[52:67], v[152:155], v[124:127], v[52:67]
    ds_read_b64_tr_b16 v[138:139], v14 offset:50176
    ds_read_b128 v[108:111], v10 offset:53248
    v_mfma_f32_32x32x16_bf16 v[84:99], v[156:159], v[124:127], v[84:99]
    ds_read_b64_tr_b16 v[140:141], v15 offset:49152
    ds_read_b64_tr_b16 v[142:143], v15 offset:50176
    v_mfma_f32_32x32x16_bf16 v[68:83], v[156:159], v[120:123], v[68:83]
    v_mfma_f32_16x16x32_bf16 v[100:103], v[152:155], v[20:23], v[100:103]
    s_waitcnt lgkmcnt(6)
    v_mfma_f32_32x32x16_bf16 v[36:51], v[160:163], v[128:131], v[36:51]
    ds_read_b128 v[112:115], v11 offset:49152
    ds_read_b64_tr_b16 v[144:145], v14 offset:53248
    v_mfma_f32_32x32x16_bf16 v[52:67], v[160:163], v[132:135], v[52:67]
    ds_read_b64_tr_b16 v[146:147], v14 offset:54272
    ds_read_b128 v[116:119], v11 offset:53248
    v_mfma_f32_32x32x16_bf16 v[84:99], v[164:167], v[132:135], v[84:99]
    ds_read_b64_tr_b16 v[148:149], v15 offset:53248
    ds_read_b64_tr_b16 v[150:151], v15 offset:54272
    v_mfma_f32_32x32x16_bf16 v[68:83], v[164:167], v[128:131], v[68:83]
    v_mfma_f32_16x16x32_bf16 v[100:103], v[160:163], v[20:23], v[100:103]
    s_waitcnt lgkmcnt(6)
    v_mfma_f32_32x32x16_bf16 v[36:51], v[136:139], v[104:107], v[36:51]
    ds_read_b128 v[120:123], v12 offset:49152
    ds_read_b64_tr_b16 v[152:153], v14 offset:57344
    v_mfma_f32_32x32x16_bf16 v[52:67], v[136:139], v[108:111], v[52:67]
    ds_read_b64_tr_b16 v[154:155], v14 offset:58368
    ds_read_b128 v[124:127], v12 offset:53248
    v_mfma_f32_32x32x16_bf16 v[84:99], v[140:143], v[108:111], v[84:99]
    ds_read_b64_tr_b16 v[156:157], v15 offset:57344
    ds_read_b64_tr_b16 v[158:159], v15 offset:58368
    v_mfma_f32_32x32x16_bf16 v[68:83], v[140:143], v[104:107], v[68:83]
    v_mfma_f32_16x16x32_bf16 v[100:103], v[136:139], v[20:23], v[100:103]
    s_waitcnt lgkmcnt(6)
    v_mfma_f32_32x32x16_bf16 v[36:51], v[144:147], v[112:115], v[36:51]
    ds_read_b128 v[128:131], v13 offset:49152
    ds_read_b64_tr_b16 v[160:161], v14 offset:61440
    v_mfma_f32_32x32x16_bf16 v[52:67], v[144:147], v[116:119], v[52:67]
    ds_read_b64_tr_b16 v[162:163], v14 offset:62464
    ds_read_b128 v[132:135], v13 offset:53248
    v_mfma_f32_32x32x16_bf16 v[84:99], v[148:151], v[116:119], v[84:99]
    ds_read_b64_tr_b16 v[164:165], v15 offset:61440
    ds_read_b64_tr_b16 v[166:167], v15 offset:62464
    v_mfma_f32_32x32x16_bf16 v[68:83], v[148:151], v[112:115], v[68:83]
    v_mfma_f32_16x16x32_bf16 v[100:103], v[144:147], v[20:23], v[100:103]
    s_waitcnt lgkmcnt(6)
    v_mfma_f32_32x32x16_bf16 v[36:51], v[152:155], v[120:123], v[36:51]
    s_waitcnt lgkmcnt(0)
    s_barrier
    ds_read_b128 v[104:107], v10 offset:0
    ds_read_b64_tr_b16 v[136:137], v14 offset:0
    v_mfma_f32_32x32x16_bf16 v[52:67], v[152:155], v[124:127], v[52:67]
    ds_read_b64_tr_b16 v[138:139], v14 offset:1024
    ds_read_b128 v[108:111], v10 offset:4096
    v_mfma_f32_32x32x16_bf16 v[84:99], v[156:159], v[124:127], v[84:99]
    ds_read_b64_tr_b16 v[140:141], v15 offset:0
    ds_read_b64_tr_b16 v[142:143], v15 offset:1024
    v_mfma_f32_32x32x16_bf16 v[68:83], v[156:159], v[120:123], v[68:83]
    v_mfma_f32_16x16x32_bf16 v[100:103], v[152:155], v[20:23], v[100:103]
    s_waitcnt lgkmcnt(6)
    v_mfma_f32_32x32x16_bf16 v[36:51], v[160:163], v[128:131], v[36:51]
    ds_read_b128 v[112:115], v11 offset:0
    ds_read_b64_tr_b16 v[144:145], v14 offset:4096
    v_mfma_f32_32x32x16_bf16 v[52:67], v[160:163], v[132:135], v[52:67]
    ds_read_b64_tr_b16 v[146:147], v14 offset:5120
    ds_read_b128 v[116:119], v11 offset:4096
    v_mfma_f32_32x32x16_bf16 v[84:99], v[164:167], v[132:135], v[84:99]
    ds_read_b64_tr_b16 v[148:149], v15 offset:4096
    ds_read_b64_tr_b16 v[150:151], v15 offset:5120
    v_mfma_f32_32x32x16_bf16 v[68:83], v[164:167], v[128:131], v[68:83]
    v_mfma_f32_16x16x32_bf16 v[100:103], v[160:163], v[20:23], v[100:103]
    s_waitcnt lgkmcnt(6)
    v_mfma_f32_32x32x16_bf16 v[36:51], v[136:139], v[104:107], v[36:51]
    ds_read_b128 v[120:123], v12 offset:0
    ds_read_b64_tr_b16 v[152:153], v14 offset:8192
    v_mfma_f32_32x32x16_bf16 v[52:67], v[136:139], v[108:111], v[52:67]
    ds_read_b64_tr_b16 v[154:155], v14 offset:9216
    ds_read_b128 v[124:127], v12 offset:4096
    v_mfma_f32_32x32x16_bf16 v[84:99], v[140:143], v[108:111], v[84:99]
    ds_read_b64_tr_b16 v[156:157], v15 offset:8192
    ds_read_b64_tr_b16 v[158:159], v15 offset:9216
    v_mfma_f32_32x32x16_bf16 v[68:83], v[140:143], v[104:107], v[68:83]
    v_mfma_f32_16x16x32_bf16 v[100:103], v[136:139], v[20:23], v[100:103]
    s_waitcnt lgkmcnt(6)
    v_mfma_f32_32x32x16_bf16 v[36:51], v[144:147], v[112:115], v[36:51]
    ds_read_b128 v[128:131], v13 offset:0
    ds_read_b64_tr_b16 v[160:161], v14 offset:12288
    v_mfma_f32_32x32x16_bf16 v[52:67], v[144:147], v[116:119], v[52:67]
    ds_read_b64_tr_b16 v[162:163], v14 offset:13312
    ds_read_b128 v[132:135], v13 offset:4096
    v_mfma_f32_32x32x16_bf16 v[84:99], v[148:151], v[116:119], v[84:99]
    ds_read_b64_tr_b16 v[164:165], v15 offset:12288
    ds_read_b64_tr_b16 v[166:167], v15 offset:13312
    v_mfma_f32_32x32x16_bf16 v[68:83], v[148:151], v[112:115], v[68:83]
    v_mfma_f32_16x16x32_bf16 v[100:103], v[144:147], v[20:23], v[100:103]
    s_waitcnt lgkmcnt(6)
    v_mfma_f32_32x32x16_bf16 v[36:51], v[152:155], v[120:123], v[36:51]
    ds_read_b128 v[104:107], v10 offset:16384
    ds_read_b64_tr_b16 v[136:137], v14 offset:16384
    v_mfma_f32_32x32x16_bf16 v[52:67], v[152:155], v[124:127], v[52:67]
    ds_read_b64_tr_b16 v[138:139], v14 offset:17408
    ds_read_b128 v[108:111], v10 offset:20480
    v_mfma_f32_32x32x16_bf16 v[84:99], v[156:159], v[124:127], v[84:99]
    ds_read_b64_tr_b16 v[140:141], v15 offset:16384
    ds_read_b64_tr_b16 v[142:143], v15 offset:17408
    v_mfma_f32_32x32x16_bf16 v[68:83], v[156:159], v[120:123], v[68:83]
    v_mfma_f32_16x16x32_bf16 v[100:103], v[152:155], v[20:23], v[100:103]
    s_waitcnt lgkmcnt(6)
    v_mfma_f32_32x32x16_bf16 v[36:51], v[160:163], v[128:131], v[36:51]
    ds_read_b128 v[112:115], v11 offset:16384
    ds_read_b64_tr_b16 v[144:145], v14 offset:20480
    v_mfma_f32_32x32x16_bf16 v[52:67], v[160:163], v[132:135], v[52:67]
    ds_read_b64_tr_b16 v[146:147], v14 offset:21504
    ds_read_b128 v[116:119], v11 offset:20480
    v_mfma_f32_32x32x16_bf16 v[84:99], v[164:167], v[132:135], v[84:99]
    ds_read_b64_tr_b16 v[148:149], v15 offset:20480
    ds_read_b64_tr_b16 v[150:151], v15 offset:21504
    v_mfma_f32_32x32x16_bf16 v[68:83], v[164:167], v[128:131], v[68:83]
    v_mfma_f32_16x16x32_bf16 v[100:103], v[160:163], v[20:23], v[100:103]
    s_waitcnt lgkmcnt(6)
    v_mfma_f32_32x32x16_bf16 v[36:51], v[136:139], v[104:107], v[36:51]
    ds_read_b128 v[120:123], v12 offset:16384
    ds_read_b64_tr_b16 v[152:153], v14 offset:24576
    v_mfma_f32_32x32x16_bf16 v[52:67], v[136:139], v[108:111], v[52:67]
    ds_read_b64_tr_b16 v[154:155], v14 offset:25600
    ds_read_b128 v[124:127], v12 offset:20480
    v_mfma_f32_32x32x16_bf16 v[84:99], v[140:143], v[108:111], v[84:99]
    ds_read_b64_tr_b16 v[156:157], v15 offset:24576
    ds_read_b64_tr_b16 v[158:159], v15 offset:25600
    v_mfma_f32_32x32x16_bf16 v[68:83], v[140:143], v[104:107], v[68:83]
    v_mfma_f32_16x16x32_bf16 v[100:103], v[136:139], v[20:23], v[100:103]
    s_waitcnt lgkmcnt(6)
    v_mfma_f32_32x32x16_bf16 v[36:51], v[144:147], v[112:115], v[36:51]
    ds_read_b128 v[128:131], v13 offset:16384
    ds_read_b64_tr_b16 v[160:161], v14 offset:28672
    v_mfma_f32_32x32x16_bf16 v[52:67], v[144:147], v[116:119], v[52:67]
    ds_read_b64_tr_b16 v[162:163], v14 offset:29696
    ds_read_b128 v[132:135], v13 offset:20480
    v_mfma_f32_32x32x16_bf16 v[84:99], v[148:151], v[116:119], v[84:99]
    ds_read_b64_tr_b16 v[164:165], v15 offset:28672
    ds_read_b64_tr_b16 v[166:167], v15 offset:29696
    v_mfma_f32_32x32x16_bf16 v[68:83], v[148:151], v[112:115], v[68:83]
    v_mfma_f32_16x16x32_bf16 v[100:103], v[144:147], v[20:23], v[100:103]
    s_waitcnt lgkmcnt(6)
    v_mfma_f32_32x32x16_bf16 v[36:51], v[152:155], v[120:123], v[36:51]
    v_mfma_f32_32x32x16_bf16 v[52:67], v[152:155], v[124:127], v[52:67]
    v_mfma_f32_32x32x16_bf16 v[84:99], v[156:159], v[124:127], v[84:99]
    v_mfma_f32_32x32x16_bf16 v[68:83], v[156:159], v[120:123], v[68:83]
    v_mfma_f32_16x16x32_bf16 v[100:103], v[152:155], v[20:23], v[100:103]
    s_waitcnt lgkmcnt(0)
    v_mfma_f32_32x32x16_bf16 v[36:51], v[160:163], v[128:131], v[36:51]
    v_mfma_f32_32x32x16_bf16 v[52:67], v[160:163], v[132:135], v[52:67]
    v_mfma_f32_32x32x16_bf16 v[84:99], v[164:167], v[132:135], v[84:99]
    v_mfma_f32_32x32x16_bf16 v[68:83], v[164:167], v[128:131], v[68:83]
    v_mfma_f32_16x16x32_bf16 v[100:103], v[160:163], v[20:23], v[100:103]
k1_epi:
    s_mov_b64 exec, s[98:99]
    s_nop 6
    ds_write_b128 v24, v[100:103]
    s_mov_b64 exec, -1
    v_mov_b32 v3, 150544
    ds_read_b32 v2, v3
k1_dead:
    s_waitcnt lgkmcnt(0)
    s_barrier
    v_readfirstlane_b32 s92, v2
    s_nop 1
    s_mul_i32 s93, s92, 0x9E3779B1
    s_xor_b32 s93, s93, 0x5bd1e995
    s_cmp_eq_u32 s11, 13
    s_cselect_b32 s40, s30, 0
    s_cmp_lg_u32 s40, 0
    s_mov_b32 s58, 0
    s_cbranch_scc1 a_done1
    ds_read_b64 v[168:169], v28
    ds_read_b64 v[170:171], v28 offset:256
    ds_read_b128 v[104:107], v26 offset:0
    ds_read_b128 v[136:139], v26 offset:512
    ds_read_b128 v[108:111], v26 offset:32
    ds_read_b128 v[140:143], v26 offset:544
    ds_read_b128 v[120:123], v27 offset:0
    ds_read_b128 v[152:155], v27 offset:512
    ds_read_b128 v[124:127], v27 offset:32
    ds_read_b128 v[156:159], v27 offset:544
    ds_read_b128 v[112:115], v26 offset:64
    ds_read_b128 v[144:147], v26 offset:576
    ds_read_b128 v[116:119], v26 offset:96
    ds_read_b128 v[148:151], v26 offset:608
    s_lshl_b32 s58, s10, 1
    s_add_u32 s58, s58, s29
    s_lshl_b32 s58, s58, 4
    s_add_u32 s58, s58, s11
    s_lshl_b32 s58, s58, 1
    s_add_u32 s58, s58, s30
    s_lshl_b32 s58, s58, 6
    s_add_u32 s58, s58, 131072
    s_waitcnt lgkmcnt(8)
    v_mov_b32 v172, v169
    v_mov_b32 v174, v171
    v_pk_fma_f32 v[176:177], v[104:105], v[172:173], v[136:137] op_sel_hi:[1,0,1] neg_lo:[1,0,0] neg_hi:[1,0,0]
    v_pk_fma_f32 v[178:179], v[106:107], v[172:173], v[138:139] op_sel_hi:[1,0,1] neg_lo:[1,0,0] neg_hi:[1,0,0]
    v_pk_fma_f32 v[180:181], v[108:109], v[172:173], v[140:141] op_sel_hi:[1,0,1] neg_lo:[1,0,0] neg_hi:[1,0,0]
    v_pk_fma_f32 v[182:183], v[110:111], v[172:173], v[142:143] op_sel_hi:[1,0,1] neg_lo:[1,0,0] neg_hi:[1,0,0]
    v_pk_fma_f32 v[36:37], v[36:37], v[168:169], v[176:177] op_sel_hi:[1,0,1]
    v_pk_fma_f32 v[38:39], v[38:39], v[168:169], v[178:179] op_sel_hi:[1,0,1]
    v_pk_fma_f32 v[40:41], v[40:41], v[168:169], v[180:181] op_sel_hi:[1,0,1]
    v_pk_fma_f32 v[42:43], v[42:43], v[168:169], v[182:183] op_sel_hi:[1,0,1]
    v_pk_mul_f32 v[176:177], v[36:37], v[36:37]
    v_pk_mul_f32 v[178:179], v[38:39], v[38:39]
    v_pk_mul_f32 v[180:181], v[40:41], v[40:41]
    v_pk_mul_f32 v[182:183], v[42:43], v[42:43]
    v_pk_fma_f32 v[176:177], v[176:177], v[32:33], v[30:31] op_sel_hi:[1,0,0]
    v_pk_fma_f32 v[178:179], v[178:179], v[32:33], v[30:31] op_sel_hi:[1,0,0]
    v_pk_fma_f32 v[180:181], v[180:181], v[32:33], v[30:31] op_sel_hi:[1,0,0]
    v_pk_fma_f32 v[182:183], v[182:183], v[32:33], v[30:31] op_sel_hi:[1,0,0]
    v_pk_mul_f32 v[176:177], v[176:177], v[36:37]
    v_pk_mul_f32 v[178:179], v[178:179], v[38:39]
    v_pk_mul_f32 v[180:181], v[180:181], v[40:41]
    v_pk_mul_f32 v[182:183], v[182:183], v[42:43]
    v_exp_f32 v176, v176
    v_exp_f32 v177, v177
    v_exp_f32 v178, v178
    v_exp_f32 v179, v179
    v_exp_f32 v180, v180
    v_exp_f32 v181, v181
    v_exp_f32 v182, v182
    v_exp_f32 v183, v183
    v_pk_add_f32 v[176:177], v[176:177], v[34:35] op_sel_hi:[1,0]
    v_pk_add_f32 v[178:179], v[178:179], v[34:35] op_sel_hi:[1,0]
    v_pk_add_f32 v[180:181], v[180:181], v[34:35] op_sel_hi:[1,0]
    v_pk_add_f32 v[182:183], v[182:183], v[34:35] op_sel_hi:[1,0]
    v_rcp_f32 v176, v176
    v_rcp_f32 v177, v177
    v_rcp_f32 v178, v178
    v_rcp_f32 v179, v179
    v_rcp_f32 v180, v180
    v_rcp_f32 v181, v181
    v_rcp_f32 v182, v182
    v_rcp_f32 v183, v183
    v_pk_mul_f32 v[36:37], v[36:37], v[176:177]
    v_pk_mul_f32 v[38:39], v[38:39], v[178:179]
    v_pk_mul_f32 v[40:41], v[40:41], v[180:181]
    v_pk_mul_f32 v[42:43], v[42:43], v[182:183]
    v_cvt_pk_bf16_f32 v184, v36, v37
    v_cvt_pk_bf16_f32 v185, v38, v39
    v_cvt_pk_bf16_f32 v186, v40, v41
    v_cvt_pk_bf16_f32 v187, v42, v43
    buffer_store_dwordx4 v[184:187], v29, s[24:27], s44 offen offset:0 sc1
    v_pk_fma_f32 v[176:177], v[104:105], v[174:175], v[136:137] op_sel_hi:[1,0,1] neg_lo:[1,0,0] neg_hi:[1,0,0]
    v_pk_fma_f32 v[178:179], v[106:107], v[174:175], v[138:139] op_sel_hi:[1,0,1] neg_lo:[1,0,0] neg_hi:[1,0,0]
    v_pk_fma_f32 v[180:181], v[108:109], v[174:175], v[140:141] op_sel_hi:[1,0,1] neg_lo:[1,0,0] neg_hi:[1,0,0]
    v_pk_fma_f32 v[182:183], v[110:111], v[174:175], v[142:143] op_sel_hi:[1,0,1] neg_lo:[1,0,0] neg_hi:[1,0,0]
    v_pk_fma_f32 v[52:53], v[52:53], v[170:171], v[176:177] op_sel_hi:[1,0,1]
    v_pk_fma_f32 v[54:55], v[54:55], v[170:171], v[178:179] op_sel_hi:[1,0,1]
    v_pk_fma_f32 v[56:57], v[56:57], v[170:171], v[180:181] op_sel_hi:[1,0,1]
    v_pk_fma_f32 v[58:59], v[58:59], v[170:171], v[182:183] op_sel_hi:[1,0,1]
    v_pk_mul_f32 v[176:177], v[52:53], v[52:53]
    v_pk_mul_f32 v[178:179], v[54:55], v[54:55]
    v_pk_mul_f32 v[180:181], v[56:57], v[56:57]
    v_pk_mul_f32 v[182:183], v[58:59], v[58:59]
    v_pk_fma_f32 v[176:177], v[176:177], v[32:33], v[30:31] op_sel_hi:[1,0,0]
    v_pk_fma_f32 v[178:179], v[178:179], v[32:33], v[30:31] op_sel_hi:[1,0,0]
    v_pk_fma_f32 v[180:181], v[180:181], v[32:33], v[30:31] op_sel_hi:[1,0,0]
    v_pk_fma_f32 v[182:183], v[182:183], v[32:33], v[30:31] op_sel_hi:[1,0,0]
    v_pk_mul_f32 v[176:177], v[176:177], v[52:53]
    v_pk_mul_f32 v[178:179], v[178:179], v[54:55]
    v_pk_mul_f32 v[180:181], v[180:181], v[56:57]
    v_pk_mul_f32 v[182:183], v[182:183], v[58:59]
    v_exp_f32 v176, v176
    v_exp_f32 v177, v177
    v_exp_f32 v178, v178
    v_exp_f32 v179, v179
    v_exp_f32 v180, v180
    v_exp_f32 v181, v181
    v_exp_f32 v182, v182
    v_exp_f32 v183, v183
    v_pk_add_f32 v[176:177], v[176:177], v[34:35] op_sel_hi:[1,0]
    v_pk_add_f32 v[178:179], v[178:179], v[34:35] op_sel_hi:[1,0]
    v_pk_add_f32 v[180:181], v[180:181], v[34:35] op_sel_hi:[1,0]
    v_pk_add_f32 v[182:183], v[182:183], v[34:35] op_sel_hi:[1,0]
    v_rcp_f32 v176, v176
    v_rcp_f32 v177, v177
    v_rcp_f32 v178, v178
    v_rcp_f32 v179, v179
    v_rcp_f32 v180, v180
    v_rcp_f32 v181, v181
    v_rcp_f32 v182, v182
    v_rcp_f32 v183, v183
    v_pk_mul_f32 v[52:53], v[52:53], v[176:177]
    v_pk_mul_f32 v[54:55], v[54:55], v[178:179]
    v_pk_mul_f32 v[56:57], v[56:57], v[180:181]
    v_pk_mul_f32 v[58:59], v[58:59], v[182:183]
    v_cvt_pk_bf16_f32 v188, v52, v53
    v_cvt_pk_bf16_f32 v189, v54, v55
    v_cvt_pk_bf16_f32 v190, v56, v57
    v_cvt_pk_bf16_f32 v191, v58, v59
    buffer_store_dwordx4 v[188:191], v29, s[24:27], s45 offen offset:0 sc1
    ds_read_b128 v[128:131], v27 offset:64
    ds_read_b128 v[160:163], v27 offset:576
    ds_read_b128 v[132:135], v27 offset:96
    ds_read_b128 v[164:167], v27 offset:608
    s_waitcnt lgkmcnt(8)
    v_pk_fma_f32 v[176:177], v[120:121], v[172:173], v[152:153] op_sel_hi:[1,0,1] neg_lo:[1,0,0] neg_hi:[1,0,0]
    v_pk_fma_f32 v[178:179], v[122:123], v[172:173], v[154:155] op_sel_hi:[1,0,1] neg_lo:[1,0,0] neg_hi:[1,0,0]
    v_pk_fma_f32 v[180:181], v[124:125], v[172:173], v[156:157] op_sel_hi:[1,0,1] neg_lo:[1,0,0] neg_hi:[1,0,0]
    v_pk_fma_f32 v[182:183], v[126:127], v[172:173], v[158:159] op_sel_hi:[1,0,1] neg_lo:[1,0,0] neg_hi:[1,0,0]
    v_pk_fma_f32 v[68:69], v[68:69], v[168:169], v[176:177] op_sel_hi:[1,0,1]
    v_pk_fma_f32 v[70:71], v[70:71], v[168:169], v[178:179] op_sel_hi:[1,0,1]
    v_pk_fma_f32 v[72:73], v[72:73], v[168:169], v[180:181] op_sel_hi:[1,0,1]
    v_pk_fma_f32 v[74:75], v[74:75], v[168:169], v[182:183] op_sel_hi:[1,0,1]
    v_pk_mul_f32 v[176:177], v[68:69], v[68:69]
    v_pk_mul_f32 v[178:179], v[70:71], v[70:71]
    v_pk_mul_f32 v[180:181], v[72:73], v[72:73]
    v_pk_mul_f32 v[182:183], v[74:75], v[74:75]
    v_pk_fma_f32 v[176:177], v[176:177], v[32:33], v[30:31] op_sel_hi:[1,0,0]
    v_pk_fma_f32 v[178:179], v[178:179], v[32:33], v[30:31] op_sel_hi:[1,0,0]
    v_pk_fma_f32 v[180:181], v[180:181], v[32:33], v[30:31] op_sel_hi:[1,0,0]
    v_pk_fma_f32 v[182:183], v[182:183], v[32:33], v[30:31] op_sel_hi:[1,0,0]
    v_pk_mul_f32 v[176:177], v[176:177], v[68:69]
    v_pk_mul_f32 v[178:179], v[178:179], v[70:71]
    v_pk_mul_f32 v[180:181], v[180:181], v[72:73]
    v_pk_mul_f32 v[182:183], v[182:183], v[74:75]
    v_exp_f32 v176, v176
    v_exp_f32 v177, v177
    v_exp_f32 v178, v178
    v_exp_f32 v179, v179
    v_exp_f32 v180, v180
    v_exp_f32 v181, v181
    v_exp_f32 v182, v182
    v_exp_f32 v183, v183
    v_pk_add_f32 v[176:177], v[176:177], v[34:35] op_sel_hi:[1,0]
    v_pk_add_f32 v[178:179], v[178:179], v[34:35] op_sel_hi:[1,0]
    v_pk_add_f32 v[180:181], v[180:181], v[34:35] op_sel_hi:[1,0]
    v_pk_add_f32 v[182:183], v[182:183], v[34:35] op_sel_hi:[1,0]
    v_rcp_f32 v176, v176
    v_rcp_f32 v177, v177
    v_rcp_f32 v178, v178
    v_rcp_f32 v179, v179
    v_rcp_f32 v180, v180
    v_rcp_f32 v181, v181
    v_rcp_f32 v182, v182
    v_rcp_f32 v183, v183
    v_pk_mul_f32 v[68:69], v[68:69], v[176:177]
    v_pk_mul_f32 v[70:71], v[70:71], v[178:179]
    v_pk_mul_f32 v[72:73], v[72:73], v[180:181]
    v_pk_mul_f32 v[74:75], v[74:75], v[182:183]
    v_cvt_pk_bf16_f32 v184, v68, v69
    v_cvt_pk_bf16_f32 v185, v70, v71
    v_cvt_pk_bf16_f32 v186, v72, v73
    v_cvt_pk_bf16_f32 v187, v74, v75
    buffer_store_dwordx4 v[184:187], v29, s[24:27], s46 offen offset:0 sc1
    v_pk_fma_f32 v[176:177], v[120:121], v[174:175], v[152:153] op_sel_hi:[1,0,1] neg_lo:[1,0,0] neg_hi:[1,0,0]
    v_pk_fma_f32 v[178:179], v[122:123], v[174:175], v[154:155] op_sel_hi:[1,0,1] neg_lo:[1,0,0] neg_hi:[1,0,0]
    v_pk_fma_f32 v[180:181], v[124:125], v[174:175], v[156:157] op_sel_hi:[1,0,1] neg_lo:[1,0,0] neg_hi:[1,0,0]
    v_pk_fma_f32 v[182:183], v[126:127], v[174:175], v[158:159] op_sel_hi:[1,0,1] neg_lo:[1,0,0] neg_hi:[1,0,0]
    v_pk_fma_f32 v[84:85], v[84:85], v[170:171], v[176:177] op_sel_hi:[1,0,1]
    v_pk_fma_f32 v[86:87], v[86:87], v[170:171], v[178:179] op_sel_hi:[1,0,1]
    v_pk_fma_f32 v[88:89], v[88:89], v[170:171], v[180:181] op_sel_hi:[1,0,1]
    v_pk_fma_f32 v[90:91], v[90:91], v[170:171], v[182:183] op_sel_hi:[1,0,1]
    v_pk_mul_f32 v[176:177], v[84:85], v[84:85]
    v_pk_mul_f32 v[178:179], v[86:87], v[86:87]
    v_pk_mul_f32 v[180:181], v[88:89], v[88:89]
    v_pk_mul_f32 v[182:183], v[90:91], v[90:91]
    v_pk_fma_f32 v[176:177], v[176:177], v[32:33], v[30:31] op_sel_hi:[1,0,0]
    v_pk_fma_f32 v[178:179], v[178:179], v[32:33], v[30:31] op_sel_hi:[1,0,0]
    v_pk_fma_f32 v[180:181], v[180:181], v[32:33], v[30:31] op_sel_hi:[1,0,0]
    v_pk_fma_f32 v[182:183], v[182:183], v[32:33], v[30:31] op_sel_hi:[1,0,0]
    v_pk_mul_f32 v[176:177], v[176:177], v[84:85]
    v_pk_mul_f32 v[178:179], v[178:179], v[86:87]
    v_pk_mul_f32 v[180:181], v[180:181], v[88:89]
    v_pk_mul_f32 v[182:183], v[182:183], v[90:91]
    v_exp_f32 v176, v176
    v_exp_f32 v177, v177
    v_exp_f32 v178, v178
    v_exp_f32 v179, v179
    v_exp_f32 v180, v180
    v_exp_f32 v181, v181
    v_exp_f32 v182, v182
    v_exp_f32 v183, v183
    v_pk_add_f32 v[176:177], v[176:177], v[34:35] op_sel_hi:[1,0]
    v_pk_add_f32 v[178:179], v[178:179], v[34:35] op_sel_hi:[1,0]
    v_pk_add_f32 v[180:181], v[180:181], v[34:35] op_sel_hi:[1,0]
    v_pk_add_f32 v[182:183], v[182:183], v[34:35] op_sel_hi:[1,0]
    v_rcp_f32 v176, v176
    v_rcp_f32 v177, v177
    v_rcp_f32 v178, v178
    v_rcp_f32 v179, v179
    v_rcp_f32 v180, v180
    v_rcp_f32 v181, v181
    v_rcp_f32 v182, v182
    v_rcp_f32 v183, v183
    v_pk_mul_f32 v[84:85], v[84:85], v[176:177]
    v_pk_mul_f32 v[86:87], v[86:87], v[178:179]
    v_pk_mul_f32 v[88:89], v[88:89], v[180:181]
    v_pk_mul_f32 v[90:91], v[90:91], v[182:183]
    v_cvt_pk_bf16_f32 v188, v84, v85
    v_cvt_pk_bf16_f32 v189, v86, v87
    v_cvt_pk_bf16_f32 v190, v88, v89
    v_cvt_pk_bf16_f32 v191, v90, v91
    buffer_store_dwordx4 v[188:191], v29, s[24:27], s47 offen offset:0 sc1
    s_waitcnt lgkmcnt(4)
    v_pk_fma_f32 v[176:177], v[112:113], v[172:173], v[144:145] op_sel_hi:[1,0,1] neg_lo:[1,0,0] neg_hi:[1,0,0]
    v_pk_fma_f32 v[178:179], v[114:115], v[172:173], v[146:147] op_sel_hi:[1,0,1] neg_lo:[1,0,0] neg_hi:[1,0,0]
    v_pk_fma_f32 v[180:181], v[116:117], v[172:173], v[148:149] op_sel_hi:[1,0,1] neg_lo:[1,0,0] neg_hi:[1,0,0]
    v_pk_fma_f32 v[182:183], v[118:119], v[172:173], v[150:151] op_sel_hi:[1,0,1] neg_lo:[1,0,0] neg_hi:[1,0,0]
    v_pk_fma_f32 v[44:45], v[44:45], v[168:169], v[176:177] op_sel_hi:[1,0,1]
    v_pk_fma_f32 v[46:47], v[46:47], v[168:169], v[178:179] op_sel_hi:[1,0,1]
    v_pk_fma_f32 v[48:49], v[48:49], v[168:169], v[180:181] op_sel_hi:[1,0,1]
    v_pk_fma_f32 v[50:51], v[50:51], v[168:169], v[182:183] op_sel_hi:[1,0,1]
    v_pk_mul_f32 v[176:177], v[44:45], v[44:45]
    v_pk_mul_f32 v[178:179], v[46:47], v[46:47]
    v_pk_mul_f32 v[180:181], v[48:49], v[48:49]
    v_pk_mul_f32 v[182:183], v[50:51], v[50:51]
    v_pk_fma_f32 v[176:177], v[176:177], v[32:33], v[30:31] op_sel_hi:[1,0,0]
    v_pk_fma_f32 v[178:179], v[178:179], v[32:33], v[30:31] op_sel_hi:[1,0,0]
    v_pk_fma_f32 v[180:181], v[180:181], v[32:33], v[30:31] op_sel_hi:[1,0,0]
    v_pk_fma_f32 v[182:183], v[182:183], v[32:33], v[30:31] op_sel_hi:[1,0,0]
    v_pk_mul_f32 v[176:177], v[176:177], v[44:45]
    v_pk_mul_f32 v[178:179], v[178:179], v[46:47]
    v_pk_mul_f32 v[180:181], v[180:181], v[48:49]
    v_pk_mul_f32 v[182:183], v[182:183], v[50:51]
    v_exp_f32 v176, v176
    v_exp_f32 v177, v177
    v_exp_f32 v178, v178
    v_exp_f32 v179, v179
    v_exp_f32 v180, v180
    v_exp_f32 v181, v181
    v_exp_f32 v182, v182
    v_exp_f32 v183, v183
    v_pk_add_f32 v[176:177], v[176:177], v[34:35] op_sel_hi:[1,0]
    v_pk_add_f32 v[178:179], v[178:179], v[34:35] op_sel_hi:[1,0]
    v_pk_add_f32 v[180:181], v[180:181], v[34:35] op_sel_hi:[1,0]
    v_pk_add_f32 v[182:183], v[182:183], v[34:35] op_sel_hi:[1,0]
    v_rcp_f32 v176, v176
    v_rcp_f32 v177, v177
    v_rcp_f32 v178, v178
    v_rcp_f32 v179, v179
    v_rcp_f32 v180, v180
    v_rcp_f32 v181, v181
    v_rcp_f32 v182, v182
    v_rcp_f32 v183, v183
    v_pk_mul_f32 v[44:45], v[44:45], v[176:177]
    v_pk_mul_f32 v[46:47], v[46:47], v[178:179]
    v_pk_mul_f32 v[48:49], v[48:49], v[180:181]
    v_pk_mul_f32 v[50:51], v[50:51], v[182:183]
    v_cvt_pk_bf16_f32 v184, v44, v45
    v_cvt_pk_bf16_f32 v185, v46, v47
    v_cvt_pk_bf16_f32 v186, v48, v49
    v_cvt_pk_bf16_f32 v187, v50, v51
    buffer_store_dwordx4 v[184:187], v29, s[24:27], s44 offen offset:1024 sc1
    v_pk_fma_f32 v[176:177], v[112:113], v[174:175], v[144:145] op_sel_hi:[1,0,1] neg_lo:[1,0,0] neg_hi:[1,0,0]
    v_pk_fma_f32 v[178:179], v[114:115], v[174:175], v[146:147] op_sel_hi:[1,0,1] neg_lo:[1,0,0] neg_hi:[1,0,0]
    v_pk_fma_f32 v[180:181], v[116:117], v[174:175], v[148:149] op_sel_hi:[1,0,1] neg_lo:[1,0,0] neg_hi:[1,0,0]
    v_pk_fma_f32 v[182:183], v[118:119], v[174:175], v[150:151] op_sel_hi:[1,0,1] neg_lo:[1,0,0] neg_hi:[1,0,0]
    v_pk_fma_f32 v[60:61], v[60:61], v[170:171], v[176:177] op_sel_hi:[1,0,1]
    v_pk_fma_f32 v[62:63], v[62:63], v[170:171], v[178:179] op_sel_hi:[1,0,1]
    v_pk_fma_f32 v[64:65], v[64:65], v[170:171], v[180:181] op_sel_hi:[1,0,1]
    v_pk_fma_f32 v[66:67], v[66:67], v[170:171], v[182:183] op_sel_hi:[1,0,1]
    v_pk_mul_f32 v[176:177], v[60:61], v[60:61]
    v_pk_mul_f32 v[178:179], v[62:63], v[62:63]
    v_pk_mul_f32 v[180:181], v[64:65], v[64:65]
    v_pk_mul_f32 v[182:183], v[66:67], v[66:67]
    v_pk_fma_f32 v[176:177], v[176:177], v[32:33], v[30:31] op_sel_hi:[1,0,0]
    v_pk_fma_f32 v[178:179], v[178:179], v[32:33], v[30:31] op_sel_hi:[1,0,0]
    v_pk_fma_f32 v[180:181], v[180:181], v[32:33], v[30:31] op_sel_hi:[1,0,0]
    v_pk_fma_f32 v[182:183], v[182:183], v[32:33], v[30:31] op_sel_hi:[1,0,0]
    v_pk_mul_f32 v[176:177], v[176:177], v[60:61]
    v_pk_mul_f32 v[178:179], v[178:179], v[62:63]
    v_pk_mul_f32 v[180:181], v[180:181], v[64:65]
    v_pk_mul_f32 v[182:183], v[182:183], v[66:67]
    v_exp_f32 v176, v176
    v_exp_f32 v177, v177
    v_exp_f32 v178, v178
    v_exp_f32 v179, v179
    v_exp_f32 v180, v180
    v_exp_f32 v181, v181
    v_exp_f32 v182, v182
    v_exp_f32 v183, v183
    v_pk_add_f32 v[176:177], v[176:177], v[34:35] op_sel_hi:[1,0]
    v_pk_add_f32 v[178:179], v[178:179], v[34:35] op_sel_hi:[1,0]
    v_pk_add_f32 v[180:181], v[180:181], v[34:35] op_sel_hi:[1,0]
    v_pk_add_f32 v[182:183], v[182:183], v[34:35] op_sel_hi:[1,0]
    v_rcp_f32 v176, v176
    v_rcp_f32 v177, v177
    v_rcp_f32 v178, v178
    v_rcp_f32 v179, v179
    v_rcp_f32 v180, v180
    v_rcp_f32 v181, v181
    v_rcp_f32 v182, v182
    v_rcp_f32 v183, v183
    v_pk_mul_f32 v[60:61], v[60:61], v[176:177]
    v_pk_mul_f32 v[62:63], v[62:63], v[178:179]
    v_pk_mul_f32 v[64:65], v[64:65], v[180:181]
    v_pk_mul_f32 v[66:67], v[66:67], v[182:183]
    v_cvt_pk_bf16_f32 v188, v60, v61
    v_cvt_pk_bf16_f32 v189, v62, v63
    v_cvt_pk_bf16_f32 v190, v64, v65
    v_cvt_pk_bf16_f32 v191, v66, v67
    buffer_store_dwordx4 v[188:191], v29, s[24:27], s45 offen offset:1024 sc1
    s_waitcnt lgkmcnt(0)
    v_pk_fma_f32 v[176:177], v[128:129], v[172:173], v[160:161] op_sel_hi:[1,0,1] neg_lo:[1,0,0] neg_hi:[1,0,0]
    v_pk_fma_f32 v[178:179], v[130:131], v[172:173], v[162:163] op_sel_hi:[1,0,1] neg_lo:[1,0,0] neg_hi:[1,0,0]
    v_pk_fma_f32 v[180:181], v[132:133], v[172:173], v[164:165] op_sel_hi:[1,0,1] neg_lo:[1,0,0] neg_hi:[1,0,0]
    v_pk_fma_f32 v[182:183], v[134:135], v[172:173], v[166:167] op_sel_hi:[1,0,1] neg_lo:[1,0,0] neg_hi:[1,0,0]
    v_pk_fma_f32 v[76:77], v[76:77], v[168:169], v[176:177] op_sel_hi:[1,0,1]
    v_pk_fma_f32 v[78:79], v[78:79], v[168:169], v[178:179] op_sel_hi:[1,0,1]
    v_pk_fma_f32 v[80:81], v[80:81], v[168:169], v[180:181] op_sel_hi:[1,0,1]
    v_pk_fma_f32 v[82:83], v[82:83], v[168:169], v[182:183] op_sel_hi:[1,0,1]
    v_pk_mul_f32 v[176:177], v[76:77], v[76:77]
    v_pk_mul_f32 v[178:179], v[78:79], v[78:79]
    v_pk_mul_f32 v[180:181], v[80:81], v[80:81]
    v_pk_mul_f32 v[182:183], v[82:83], v[82:83]
    v_pk_fma_f32 v[176:177], v[176:177], v[32:33], v[30:31] op_sel_hi:[1,0,0]
    v_pk_fma_f32 v[178:179], v[178:179], v[32:33], v[30:31] op_sel_hi:[1,0,0]
    v_pk_fma_f32 v[180:181], v[180:181], v[32:33], v[30:31] op_sel_hi:[1,0,0]
    v_pk_fma_f32 v[182:183], v[182:183], v[32:33], v[30:31] op_sel_hi:[1,0,0]
    v_pk_mul_f32 v[176:177], v[176:177], v[76:77]
    v_pk_mul_f32 v[178:179], v[178:179], v[78:79]
    v_pk_mul_f32 v[180:181], v[180:181], v[80:81]
    v_pk_mul_f32 v[182:183], v[182:183], v[82:83]
    v_exp_f32 v176, v176
    v_exp_f32 v177, v177
    v_exp_f32 v178, v178
    v_exp_f32 v179, v179
    v_exp_f32 v180, v180
    v_exp_f32 v181, v181
    v_exp_f32 v182, v182
    v_exp_f32 v183, v183
    v_pk_add_f32 v[176:177], v[176:177], v[34:35] op_sel_hi:[1,0]
    v_pk_add_f32 v[178:179], v[178:179], v[34:35] op_sel_hi:[1,0]
    v_pk_add_f32 v[180:181], v[180:181], v[34:35] op_sel_hi:[1,0]
    v_pk_add_f32 v[182:183], v[182:183], v[34:35] op_sel_hi:[1,0]
    v_rcp_f32 v176, v176
    v_rcp_f32 v177, v177
    v_rcp_f32 v178, v178
    v_rcp_f32 v179, v179
    v_rcp_f32 v180, v180
    v_rcp_f32 v181, v181
    v_rcp_f32 v182, v182
    v_rcp_f32 v183, v183
    v_pk_mul_f32 v[76:77], v[76:77], v[176:177]
    v_pk_mul_f32 v[78:79], v[78:79], v[178:179]
    v_pk_mul_f32 v[80:81], v[80:81], v[180:181]
    v_pk_mul_f32 v[82:83], v[82:83], v[182:183]
    v_cvt_pk_bf16_f32 v184, v76, v77
    v_cvt_pk_bf16_f32 v185, v78, v79
    v_cvt_pk_bf16_f32 v186, v80, v81
    v_cvt_pk_bf16_f32 v187, v82, v83
    buffer_store_dwordx4 v[184:187], v29, s[24:27], s46 offen offset:1024 sc1
    v_pk_fma_f32 v[176:177], v[128:129], v[174:175], v[160:161] op_sel_hi:[1,0,1] neg_lo:[1,0,0] neg_hi:[1,0,0]
    v_pk_fma_f32 v[178:179], v[130:131], v[174:175], v[162:163] op_sel_hi:[1,0,1] neg_lo:[1,0,0] neg_hi:[1,0,0]
    v_pk_fma_f32 v[180:181], v[132:133], v[174:175], v[164:165] op_sel_hi:[1,0,1] neg_lo:[1,0,0] neg_hi:[1,0,0]
    v_pk_fma_f32 v[182:183], v[134:135], v[174:175], v[166:167] op_sel_hi:[1,0,1] neg_lo:[1,0,0] neg_hi:[1,0,0]
    v_pk_fma_f32 v[92:93], v[92:93], v[170:171], v[176:177] op_sel_hi:[1,0,1]
    v_pk_fma_f32 v[94:95], v[94:95], v[170:171], v[178:179] op_sel_hi:[1,0,1]
    v_pk_fma_f32 v[96:97], v[96:97], v[170:171], v[180:181] op_sel_hi:[1,0,1]
    v_pk_fma_f32 v[98:99], v[98:99], v[170:171], v[182:183] op_sel_hi:[1,0,1]
    v_pk_mul_f32 v[176:177], v[92:93], v[92:93]
    v_pk_mul_f32 v[178:179], v[94:95], v[94:95]
    v_pk_mul_f32 v[180:181], v[96:97], v[96:97]
    v_pk_mul_f32 v[182:183], v[98:99], v[98:99]
    v_pk_fma_f32 v[176:177], v[176:177], v[32:33], v[30:31] op_sel_hi:[1,0,0]
    v_pk_fma_f32 v[178:179], v[178:179], v[32:33], v[30:31] op_sel_hi:[1,0,0]
    v_pk_fma_f32 v[180:181], v[180:181], v[32:33], v[30:31] op_sel_hi:[1,0,0]
    v_pk_fma_f32 v[182:183], v[182:183], v[32:33], v[30:31] op_sel_hi:[1,0,0]
    v_pk_mul_f32 v[176:177], v[176:177], v[92:93]
    v_pk_mul_f32 v[178:179], v[178:179], v[94:95]
    v_pk_mul_f32 v[180:181], v[180:181], v[96:97]
    v_pk_mul_f32 v[182:183], v[182:183], v[98:99]
    v_exp_f32 v176, v176
    v_exp_f32 v177, v177
    v_exp_f32 v178, v178
    v_exp_f32 v179, v179
    v_exp_f32 v180, v180
    v_exp_f32 v181, v181
    v_exp_f32 v182, v182
    v_exp_f32 v183, v183
    v_pk_add_f32 v[176:177], v[176:177], v[34:35] op_sel_hi:[1,0]
    v_pk_add_f32 v[178:179], v[178:179], v[34:35] op_sel_hi:[1,0]
    v_pk_add_f32 v[180:181], v[180:181], v[34:35] op_sel_hi:[1,0]
    v_pk_add_f32 v[182:183], v[182:183], v[34:35] op_sel_hi:[1,0]
    v_rcp_f32 v176, v176
    v_rcp_f32 v177, v177
    v_rcp_f32 v178, v178
    v_rcp_f32 v179, v179
    v_rcp_f32 v180, v180
    v_rcp_f32 v181, v181
    v_rcp_f32 v182, v182
    v_rcp_f32 v183, v183
    v_pk_mul_f32 v[92:93], v[92:93], v[176:177]
    v_pk_mul_f32 v[94:95], v[94:95], v[178:179]
    v_pk_mul_f32 v[96:97], v[96:97], v[180:181]
    v_pk_mul_f32 v[98:99], v[98:99], v[182:183]
    v_cvt_pk_bf16_f32 v188, v92, v93
    v_cvt_pk_bf16_f32 v189, v94, v95
    v_cvt_pk_bf16_f32 v190, v96, v97
    v_cvt_pk_bf16_f32 v191, v98, v99
    buffer_store_dwordx4 v[188:191], v29, s[24:27], s47 offen offset:1024 sc1
    s_waitcnt vmcnt(0)
    s_mov_b32 s60, s6
    s_mov_b32 s61, s7
    s_mov_b32 s62, 524288
    s_mov_b32 s63, 0x00020000
    v_mov_b32 v246, s92
    v_mov_b32 v247, s93
    v_and_b32 v248, 63, v0
    v_lshlrev_b32 v248, 3, v248
    s_mov_b64 exec, 0xff
    buffer_store_dwordx2 v[246:247], v248, s[60:63], s58 offen sc1
    s_mov_b64 exec, -1
nofl3:
a_done1:
    s_cmp_ge_u32 s2, 96
    s_cbranch_scc1 k2_comp
a_done2:
    s_barrier
    s_cmp_lt_u32 s2, 82
    s_cbranch_scc1 k2_fft
    s_branch k3_start
k1_fft:
    s_and_b32 s10, s4, 3
    s_lshl_b32 s10, s10, 3
    s_and_b32 s4, s4, 4
    s_add_u32 s4, s4, s10
    s_add_u32 s4, s4, s5
    s_sub_u32 s4, s4, 28
    s_lshl_b32 s32, s4, 3
    s_add_u32 s32, s32, s3
    s_lshr_b32 s33, s32, 5
    s_lshl_b32 s33, s33, 7
    s_and_b32 s34, s32, 31
    s_add_u32 s33, s33, s34
    s_mul_i32 s34, s33, 1280
    s_add_u32 s35, s34, 1310720
    v_and_b32 v1, 63, v0
    v_lshrrev_b32 v2, 4, v1
    v_and_b32 v3, 15, v0
    v_mul_u32_u24 v4, 40960, v2
    v_lshl_add_u32 v4, v3, 4, v4
    v_mov_b32 v5, 150532
    v_mov_b32 v6, 0
    ds_write2_b32 v5, v6, v6 offset0:0 offset1:1
    s_waitcnt lgkmcnt(0)
    s_mov_b32 s12, s52
    s_mov_b32 s13, s53
    s_mov_b32 s14, 2621440
    s_mov_b32 s15, 0x00020000
    buffer_load_dwordx4 v[8:11], v4, s[12:15], s34 offen offset:0
    buffer_load_dwordx4 v[12:15], v4, s[12:15], s34 offen offset:256
    buffer_load_dwordx4 v[16:19], v4, s[12:15], s34 offen offset:512
    buffer_load_dwordx4 v[20:23], v4, s[12:15], s34 offen offset:768
    buffer_load_dwordx4 v[24:27], v4, s[12:15], s34 offen offset:1024
    buffer_load_dwordx4 v[28:31], v4, s[12:15], s35 offen offset:0
    buffer_load_dwordx4 v[32:35], v4, s[12:15], s35 offen offset:256
    buffer_load_dwordx4 v[36:39], v4, s[12:15], s35 offen offset:512
    buffer_load_dwordx4 v[40:43], v4, s[12:15], s35 offen offset:768
    buffer_load_dwordx4 v[44:47], v4, s[12:15], s35 offen offset:1024
    s_load_dwordx8 s[20:27], s[0:1], 56
    v_cvt_f32_u32 v110, v3
    v_lshlrev_b32 v6, 2, v2
    v_cvt_f32_u32 v111, v6
    v_mul_f32 v113, 0x3d4ccccd, v110
    v_mul_f32 v112, v113, v111
    v_cos_f32 v116, v112
    v_sin_f32 v124, v112
    v_fmamk_f32 v125, v113, 0x3f800000, v112
    v_cos_f32 v117, v125
    v_sin_f32 v125, v125
    v_fmamk_f32 v126, v113, 0x40000000, v112
    v_cos_f32 v118, v126
    v_sin_f32 v126, v126
    v_fmamk_f32 v127, v113, 0x40400000, v112
    v_cos_f32 v119, v127
    v_sin_f32 v127, v127
    v_mul_f32 v113, 0x3d4ccccd, v110
    v_mul_f32 v128, 0x41800000, v113
    v_cos_f32 v120, v128
    v_sin_f32 v128, v128
    v_mul_f32 v129, 0x41880000, v113
    v_cos_f32 v121, v129
    v_sin_f32 v129, v129
    v_mul_f32 v130, 0x41900000, v113
    v_cos_f32 v122, v130
    v_sin_f32 v130, v130
    v_mul_f32 v131, 0x41980000, v113
    v_cos_f32 v123, v131
    v_sin_f32 v131, v131
    v_cmp_eq_u32 vcc, 0, v2
    v_cvt_pk_bf16_f32 v48, v116, v117
    v_cvt_pk_bf16_f32 v52, -v124, -v125
    v_cvt_pk_bf16_f32 v49, v118, v119
    v_cvt_pk_bf16_f32 v53, -v126, -v127
    v_cvt_pk_bf16_f32 v50, v120, v121
    v_cvt_pk_bf16_f32 v54, -v128, -v129
    v_cvt_pk_bf16_f32 v51, v122, v123
    v_cvt_pk_bf16_f32 v55, -v130, -v131
    v_cndmask_b32 v50, 0, v50, vcc
    v_cndmask_b32 v54, 0, v54, vcc
    v_cndmask_b32 v51, 0, v51, vcc
    v_cndmask_b32 v55, 0, v55, vcc
    v_mul_f32 v113, 0x3acccccd, v110
    v_mul_f32 v112, v113, v111
    v_cos_f32 v56, v112
    v_sin_f32 v64, v112
    v_fmamk_f32 v65, v113, 0x3f800000, v112
    v_cos_f32 v57, v65
    v_sin_f32 v65, v65
    v_fmamk_f32 v66, v113, 0x40000000, v112
    v_cos_f32 v58, v66
    v_sin_f32 v66, v66
    v_fmamk_f32 v67, v113, 0x40400000, v112
    v_cos_f32 v59, v67
    v_sin_f32 v67, v67
    v_fmamk_f32 v68, v113, 0x41800000, v112
    v_cos_f32 v60, v68
    v_sin_f32 v68, v68
    v_fmamk_f32 v69, v113, 0x41880000, v112
    v_cos_f32 v61, v69
    v_sin_f32 v69, v69
    v_fmamk_f32 v70, v113, 0x41900000, v112
    v_cos_f32 v62, v70
    v_sin_f32 v70, v70
    v_fmamk_f32 v71, v113, 0x41980000, v112
    v_cos_f32 v63, v71
    v_sin_f32 v71, v71
    v_mul_f32 v113, 0x3d000000, v110
    v_mul_f32 v112, v113, v111
    v_cos_f32 v116, v112
    v_sin_f32 v124, v112
    v_fmamk_f32 v125, v113, 0x3f800000, v112
    v_cos_f32 v117, v125
    v_sin_f32 v125, v125
    v_fmamk_f32 v126, v113, 0x40000000, v112
    v_cos_f32 v118, v126
    v_sin_f32 v126, v126
    v_fmamk_f32 v127, v113, 0x40400000, v112
    v_cos_f32 v119, v127
    v_sin_f32 v127, v127
    v_lshlrev_b32 v114, 31, v3
    v_xor_b32 v120, v114, v116
    v_xor_b32 v128, v114, v124
    v_xor_b32 v121, v114, v117
    v_xor_b32 v129, v114, v125
    v_xor_b32 v122, v114, v118
    v_xor_b32 v130, v114, v126
    v_xor_b32 v123, v114, v119
    v_xor_b32 v131, v114, v127
    v_cvt_pk_bf16_f32 v72, v116, v124
    v_cvt_pk_bf16_f32 v76, -v124, v116
    v_cvt_pk_bf16_f32 v73, v117, v125
    v_cvt_pk_bf16_f32 v77, -v125, v117
    v_cvt_pk_bf16_f32 v74, v118, v126
    v_cvt_pk_bf16_f32 v78, -v126, v118
    v_cvt_pk_bf16_f32 v75, v119, v127
    v_cvt_pk_bf16_f32 v79, -v127, v119
    v_cvt_pk_bf16_f32 v80, v120, v128
    v_cvt_pk_bf16_f32 v84, -v128, v120
    v_cvt_pk_bf16_f32 v81, v121, v129
    v_cvt_pk_bf16_f32 v85, -v129, v121
    v_cvt_pk_bf16_f32 v82, v122, v130
    v_cvt_pk_bf16_f32 v86, -v130, v122
    v_cvt_pk_bf16_f32 v83, v123, v131
    v_cvt_pk_bf16_f32 v87, -v131, v123
    v_cvt_pk_bf16_f32 v88, v116, v124
    v_cvt_pk_bf16_f32 v92, -v124, v116
    v_cvt_pk_bf16_f32 v89, -v117, -v125
    v_cvt_pk_bf16_f32 v93, v125, -v117
    v_cvt_pk_bf16_f32 v90, v118, v126
    v_cvt_pk_bf16_f32 v94, -v126, v118
    v_cvt_pk_bf16_f32 v91, -v119, -v127
    v_cvt_pk_bf16_f32 v95, v127, -v119
    v_cvt_pk_bf16_f32 v96, v120, v128
    v_cvt_pk_bf16_f32 v100, -v128, v120
    v_cvt_pk_bf16_f32 v97, -v121, -v129
    v_cvt_pk_bf16_f32 v101, v129, -v121
    v_cvt_pk_bf16_f32 v98, v122, v130
    v_cvt_pk_bf16_f32 v102, -v130, v122
    v_cvt_pk_bf16_f32 v99, -v123, -v131
    v_cvt_pk_bf16_f32 v103, v131, -v123
    s_mul_i32 s37, s3, 10240
    v_mul_u32_u24 v104, 1280, v2
    v_lshl_add_u32 v107, v3, 4, v104
    v_add_u32 v104, s37, v107
    v_bfe_u32 v4, v0, 2, 2
    v_and_b32 v5, 3, v0
    v_lshlrev_b32 v5, 3, v5
    v_lshl_add_u32 v5, v4, 6, v5
    v_add_u32 v5, s37, v5
    v_lshl_add_u32 v105, v2, 8, v5
    v_add_u32 v106, 1024, v5
    v_sub_u32 v108, 4160, v107
    v_mov_b32 v6, 0x40000000
    v_cmp_gt_u32 vcc, 11, v3
    s_nop 1
    v_cndmask_b32 v107, v6, v107, vcc
    v_subrev_u32 v4, 1, v3
    v_cmp_eq_u32 s[38:39], 0, v1
    v_cmp_gt_u32 vcc, 9, v4
    s_nop 0
    v_cndmask_b32 v109, v6, v108, s[38:39]
    v_cndmask_b32 v109, v109, v108, vcc
    v_cndmask_b32 v108, v6, v108, vcc
    s_waitcnt lgkmcnt(0)
    s_mov_b64 s[6:7], s[26:27]
    s_mov_b64 s[86:87], s[52:53]
    s_mov_b64 s[40:41], s[54:55]
    s_mov_b64 s[42:43], s[56:57]
    s_mov_b64 s[46:47], s[62:63]
    s_mov_b64 s[80:81], s[64:65]
    s_mov_b64 s[82:83], s[20:21]
    s_mov_b64 s[84:85], s[22:23]
    s_load_dword s92, s[6:7], 0
    s_add_u32 s24, s6, 8388608
    s_addc_u32 s25, s7, 0
    s_mov_b32 s26, 2686976
    s_mov_b32 s27, 0x00020000
    s_setprio 2
    s_waitcnt vmcnt(5)
    v_lshlrev_b32 v112, 16, v8
    v_and_b32 v113, 0xffff0000, v8
    v_lshlrev_b32 v114, 16, v9
    v_and_b32 v115, 0xffff0000, v9
    v_lshlrev_b32 v116, 16, v10
    v_and_b32 v117, 0xffff0000, v10
    v_lshlrev_b32 v118, 16, v11
    v_and_b32 v119, 0xffff0000, v11
    v_lshlrev_b32 v120, 16, v12
    v_and_b32 v121, 0xffff0000, v12
    v_lshlrev_b32 v122, 16, v13
    v_and_b32 v123, 0xffff0000, v13
    v_lshlrev_b32 v124, 16, v14
    v_and_b32 v125, 0xffff0000, v14
    v_lshlrev_b32 v126, 16, v15
    v_and_b32 v127, 0xffff0000, v15
    v_lshlrev_b32 v128, 16, v16
    v_and_b32 v129, 0xffff0000, v16
    v_lshlrev_b32 v130, 16, v17
    v_and_b32 v131, 0xffff0000, v17
    v_lshlrev_b32 v132, 16, v18
    v_and_b32 v133, 0xffff0000, v18
    v_lshlrev_b32 v134, 16, v19
    v_and_b32 v135, 0xffff0000, v19
    v_lshlrev_b32 v136, 16, v20
    v_and_b32 v137, 0xffff0000, v20
    v_lshlrev_b32 v138, 16, v21
    v_and_b32 v139, 0xffff0000, v21
    v_lshlrev_b32 v140, 16, v22
    v_and_b32 v141, 0xffff0000, v22
    v_lshlrev_b32 v142, 16, v23
    v_and_b32 v143, 0xffff0000, v23
    v_lshlrev_b32 v144, 16, v24
    v_and_b32 v145, 0xffff0000, v24
    v_lshlrev_b32 v146, 16, v25
    v_and_b32 v147, 0xffff0000, v25
    v_lshlrev_b32 v148, 16, v26
    v_and_b32 v149, 0xffff0000, v26
    v_lshlrev_b32 v150, 16, v27
    v_and_b32 v151, 0xffff0000, v27
    v_pk_add_f32 v[196:197], v[112:113], v[114:115]
    v_pk_mul_f32 v[206:207], v[112:113], v[112:113]
    v_pk_add_f32 v[210:211], v[116:117], v[118:119]
    v_pk_mul_f32 v[212:213], v[114:115], v[114:115]
    v_pk_fma_f32 v[206:207], v[116:117], v[116:117], v[206:207]
    v_pk_fma_f32 v[212:213], v[118:119], v[118:119], v[212:213]
    v_pk_add_f32 v[196:197], v[196:197], v[120:121]
    v_pk_fma_f32 v[206:207], v[120:121], v[120:121], v[206:207]
    v_pk_add_f32 v[210:211], v[210:211], v[122:123]
    v_pk_fma_f32 v[212:213], v[122:123], v[122:123], v[212:213]
    v_pk_add_f32 v[196:197], v[196:197], v[124:125]
    v_pk_fma_f32 v[206:207], v[124:125], v[124:125], v[206:207]
    v_pk_add_f32 v[210:211], v[210:211], v[126:127]
    v_pk_fma_f32 v[212:213], v[126:127], v[126:127], v[212:213]
    v_pk_add_f32 v[196:197], v[196:197], v[128:129]
    v_pk_fma_f32 v[206:207], v[128:129], v[128:129], v[206:207]
    v_pk_add_f32 v[210:211], v[210:211], v[130:131]
    v_pk_fma_f32 v[212:213], v[130:131], v[130:131], v[212:213]
    v_pk_add_f32 v[196:197], v[196:197], v[132:133]
    v_pk_fma_f32 v[206:207], v[132:133], v[132:133], v[206:207]
    v_pk_add_f32 v[210:211], v[210:211], v[134:135]
    v_pk_fma_f32 v[212:213], v[134:135], v[134:135], v[212:213]
    v_pk_add_f32 v[196:197], v[196:197], v[136:137]
    v_pk_fma_f32 v[206:207], v[136:137], v[136:137], v[206:207]
    v_pk_add_f32 v[210:211], v[210:211], v[138:139]
    v_pk_fma_f32 v[212:213], v[138:139], v[138:139], v[212:213]
    v_pk_add_f32 v[196:197], v[196:197], v[140:141]
    v_pk_fma_f32 v[206:207], v[140:141], v[140:141], v[206:207]
    v_pk_add_f32 v[210:211], v[210:211], v[142:143]
    v_pk_fma_f32 v[212:213], v[142:143], v[142:143], v[212:213]
    v_pk_add_f32 v[196:197], v[196:197], v[144:145]
    v_pk_fma_f32 v[206:207], v[144:145], v[144:145], v[206:207]
    v_pk_add_f32 v[210:211], v[210:211], v[146:147]
    v_pk_fma_f32 v[212:213], v[146:147], v[146:147], v[212:213]
    v_pk_add_f32 v[196:197], v[196:197], v[148:149]
    v_pk_fma_f32 v[206:207], v[148:149], v[148:149], v[206:207]
    v_pk_add_f32 v[210:211], v[210:211], v[150:151]
    v_pk_fma_f32 v[212:213], v[150:151], v[150:151], v[212:213]
    v_pk_add_f32 v[196:197], v[196:197], v[210:211]
    v_pk_add_f32 v[206:207], v[206:207], v[212:213]
    v_add_f32 v196, v196, v197
    v_add_f32 v206, v206, v207
    s_waitcnt vmcnt(0)
    v_lshlrev_b32 v152, 16, v28
    v_and_b32 v153, 0xffff0000, v28
    v_lshlrev_b32 v154, 16, v29
    v_and_b32 v155, 0xffff0000, v29
    v_lshlrev_b32 v156, 16, v30
    v_and_b32 v157, 0xffff0000, v30
    v_lshlrev_b32 v158, 16, v31
    v_and_b32 v159, 0xffff0000, v31
    v_lshlrev_b32 v160, 16, v32
    v_and_b32 v161, 0xffff0000, v32
    v_lshlrev_b32 v162, 16, v33
    v_and_b32 v163, 0xffff0000, v33
    v_lshlrev_b32 v164, 16, v34
    v_and_b32 v165, 0xffff0000, v34
    v_lshlrev_b32 v166, 16, v35
    v_and_b32 v167, 0xffff0000, v35
    v_lshlrev_b32 v168, 16, v36
    v_and_b32 v169, 0xffff0000, v36
    v_lshlrev_b32 v170, 16, v37
    v_and_b32 v171, 0xffff0000, v37
    v_lshlrev_b32 v172, 16, v38
    v_and_b32 v173, 0xffff0000, v38
    v_lshlrev_b32 v174, 16, v39
    v_and_b32 v175, 0xffff0000, v39
    v_lshlrev_b32 v176, 16, v40
    v_and_b32 v177, 0xffff0000, v40
    v_lshlrev_b32 v178, 16, v41
    v_and_b32 v179, 0xffff0000, v41
    v_lshlrev_b32 v180, 16, v42
    v_and_b32 v181, 0xffff0000, v42
    v_lshlrev_b32 v182, 16, v43
    v_and_b32 v183, 0xffff0000, v43
    v_lshlrev_b32 v184, 16, v44
    v_and_b32 v185, 0xffff0000, v44
    v_lshlrev_b32 v186, 16, v45
    v_and_b32 v187, 0xffff0000, v45
    v_lshlrev_b32 v188, 16, v46
    v_and_b32 v189, 0xffff0000, v46
    v_lshlrev_b32 v190, 16, v47
    v_and_b32 v191, 0xffff0000, v47
    v_pk_add_f32 v[198:199], v[152:153], v[154:155]
    v_pk_mul_f32 v[208:209], v[152:153], v[152:153]
    v_pk_add_f32 v[210:211], v[156:157], v[158:159]
    v_pk_mul_f32 v[212:213], v[154:155], v[154:155]
    v_pk_fma_f32 v[208:209], v[156:157], v[156:157], v[208:209]
    v_pk_fma_f32 v[212:213], v[158:159], v[158:159], v[212:213]
    v_pk_add_f32 v[198:199], v[198:199], v[160:161]
    v_pk_fma_f32 v[208:209], v[160:161], v[160:161], v[208:209]
    v_pk_add_f32 v[210:211], v[210:211], v[162:163]
    v_pk_fma_f32 v[212:213], v[162:163], v[162:163], v[212:213]
    v_pk_add_f32 v[198:199], v[198:199], v[164:165]
    v_pk_fma_f32 v[208:209], v[164:165], v[164:165], v[208:209]
    v_pk_add_f32 v[210:211], v[210:211], v[166:167]
    v_pk_fma_f32 v[212:213], v[166:167], v[166:167], v[212:213]
    v_pk_add_f32 v[198:199], v[198:199], v[168:169]
    v_pk_fma_f32 v[208:209], v[168:169], v[168:169], v[208:209]
    v_pk_add_f32 v[210:211], v[210:211], v[170:171]
    v_pk_fma_f32 v[212:213], v[170:171], v[170:171], v[212:213]
    v_pk_add_f32 v[198:199], v[198:199], v[172:173]
    v_pk_fma_f32 v[208:209], v[172:173], v[172:173], v[208:209]
    v_pk_add_f32 v[210:211], v[210:211], v[174:175]
    v_pk_fma_f32 v[212:213], v[174:175], v[174:175], v[212:213]
    v_pk_add_f32 v[198:199], v[198:199], v[176:177]
    v_pk_fma_f32 v[208:209], v[176:177], v[176:177], v[208:209]
    v_pk_add_f32 v[210:211], v[210:211], v[178:179]
    v_pk_fma_f32 v[212:213], v[178:179], v[178:179], v[212:213]
    v_pk_add_f32 v[198:199], v[198:199], v[180:181]
    v_pk_fma_f32 v[208:209], v[180:181], v[180:181], v[208:209]
    v_pk_add_f32 v[210:211], v[210:211], v[182:183]
    v_pk_fma_f32 v[212:213], v[182:183], v[182:183], v[212:213]
    v_pk_add_f32 v[198:199], v[198:199], v[184:185]
    v_pk_fma_f32 v[208:209], v[184:185], v[184:185], v[208:209]
    v_pk_add_f32 v[210:211], v[210:211], v[186:187]
    v_pk_fma_f32 v[212:213], v[186:187], v[186:187], v[212:213]
    v_pk_add_f32 v[198:199], v[198:199], v[188:189]
    v_pk_fma_f32 v[208:209], v[188:189], v[188:189], v[208:209]
    v_pk_add_f32 v[210:211], v[210:211], v[190:191]
    v_pk_fma_f32 v[212:213], v[190:191], v[190:191], v[212:213]
    v_pk_add_f32 v[198:199], v[198:199], v[210:211]
    v_pk_add_f32 v[208:209], v[208:209], v[212:213]
    v_add_f32 v198, v198, v199
    v_add_f32 v208, v208, v209
    v_add_f32_dpp v196, v196, v196 row_ror:8 row_mask:0xf bank_mask:0xf
    v_add_f32_dpp v206, v206, v206 row_ror:8 row_mask:0xf bank_mask:0xf
    v_add_f32_dpp v198, v198, v198 row_ror:8 row_mask:0xf bank_mask:0xf
    v_add_f32_dpp v208, v208, v208 row_ror:8 row_mask:0xf bank_mask:0xf
    v_add_f32_dpp v196, v196, v196 row_ror:4 row_mask:0xf bank_mask:0xf
    v_add_f32_dpp v206, v206, v206 row_ror:4 row_mask:0xf bank_mask:0xf
    v_add_f32_dpp v198, v198, v198 row_ror:4 row_mask:0xf bank_mask:0xf
    v_add_f32_dpp v208, v208, v208 row_ror:4 row_mask:0xf bank_mask:0xf
    v_add_f32_dpp v196, v196, v196 row_ror:2 row_mask:0xf bank_mask:0xf
    v_add_f32_dpp v206, v206, v206 row_ror:2 row_mask:0xf bank_mask:0xf
    v_add_f32_dpp v198, v198, v198 row_ror:2 row_mask:0xf bank_mask:0xf
    v_add_f32_dpp v208, v208, v208 row_ror:2 row_mask:0xf bank_mask:0xf
    v_add_f32_dpp v196, v196, v196 row_ror:1 row_mask:0xf bank_mask:0xf
    v_add_f32_dpp v206, v206, v206 row_ror:1 row_mask:0xf bank_mask:0xf
    v_add_f32_dpp v198, v198, v198 row_ror:1 row_mask:0xf bank_mask:0xf
    v_add_f32_dpp v208, v208, v208 row_ror:1 row_mask:0xf bank_mask:0xf
    v_mul_f32 v196, 0x3acccccd, v196
    v_mul_f32 v206, 0x3acccccd, v206
    v_fma_f32 v206, -v196, v196, v206
    v_cvt_pk_bf16_f32 v200, v196, v196
    v_and_b32 v200, 0xffff0000, v200
    v_mul_f32 v198, 0x3acccccd, v198
    v_mul_f32 v208, 0x3acccccd, v208
    v_fma_f32 v208, -v198, v198, v208
    v_cvt_pk_bf16_f32 v202, v198, v198
    v_and_b32 v202, 0xffff0000, v202
    v_max_f32 v192, 0, v206
    v_cvt_pk_bf16_f32 v192, v192, v192
    v_and_b32 v192, 0xffff0000, v192
    v_add_f32 v192, 0x3727c5ac, v192
    v_cvt_pk_bf16_f32 v192, v192, v192
    v_and_b32 v192, 0xffff0000, v192
    v_sqrt_f32 v192, v192
    s_nop 0
    v_cvt_pk_bf16_f32 v192, v192, v192
    v_and_b32 v192, 0xffff0000, v192
    v_rcp_f32 v192, v192
    v_max_f32 v194, 0, v208
    v_cvt_pk_bf16_f32 v194, v194, v194
    v_and_b32 v194, 0xffff0000, v194
    v_add_f32 v194, 0x3727c5ac, v194
    v_cvt_pk_bf16_f32 v194, v194, v194
    v_and_b32 v194, 0xffff0000, v194
    v_sqrt_f32 v194, v194
    s_nop 0
    v_cvt_pk_bf16_f32 v194, v194, v194
    v_and_b32 v194, 0xffff0000, v194
    v_rcp_f32 v194, v194
    v_mul_f32 v193, v192, v200
    v_mul_f32 v200, v192, v200
    v_mul_f32 v195, v194, v202
    v_mul_f32 v202, v194, v202
    s_add_u32 s16, s6, 15728640
    s_addc_u32 s17, s7, 0
    s_mov_b32 s18, 32768
    s_mov_b32 s19, 0x00020000
    v_lshlrev_b32 v204, 4, v3
    v_lshl_add_u32 v204, v2, 5, v204
    s_lshl_b32 s54, s32, 7
    s_mov_b32 exec_lo, 0x00030003
    s_mov_b32 exec_hi, 0x00030003
    buffer_store_dwordx4 v[192:195], v204, s[16:19], s54 offen sc1
    s_mov_b64 exec, -1
    s_setprio 0
    v_pk_fma_f32 v[196:197], v[112:113], v[192:193], v[200:201] op_sel_hi:[1,0,0] neg_lo:[0,0,1] neg_hi:[0,0,1]
    v_pk_fma_f32 v[152:153], v[152:153], v[194:195], v[202:203] op_sel_hi:[1,0,0] neg_lo:[0,0,1] neg_hi:[0,0,1]
    v_pk_add_f32 v[112:113], v[196:197], v[152:153]
    v_pk_add_f32 v[152:153], v[196:197], v[152:153] neg_lo:[0,1] neg_hi:[0,1]
    v_cvt_pk_bf16_f32 v8, v112, v113
    v_cvt_pk_bf16_f32 v28, v152, v153
    v_pk_fma_f32 v[198:199], v[114:115], v[192:193], v[200:201] op_sel_hi:[1,0,0] neg_lo:[0,0,1] neg_hi:[0,0,1]
    v_pk_fma_f32 v[154:155], v[154:155], v[194:195], v[202:203] op_sel_hi:[1,0,0] neg_lo:[0,0,1] neg_hi:[0,0,1]
    v_pk_add_f32 v[114:115], v[198:199], v[154:155]
    v_pk_add_f32 v[154:155], v[198:199], v[154:155] neg_lo:[0,1] neg_hi:[0,1]
    v_cvt_pk_bf16_f32 v9, v114, v115
    v_cvt_pk_bf16_f32 v29, v154, v155
    v_pk_fma_f32 v[196:197], v[116:117], v[192:193], v[200:201] op_sel_hi:[1,0,0] neg_lo:[0,0,1] neg_hi:[0,0,1]
    v_pk_fma_f32 v[156:157], v[156:157], v[194:195], v[202:203] op_sel_hi:[1,0,0] neg_lo:[0,0,1] neg_hi:[0,0,1]
    v_pk_add_f32 v[116:117], v[196:197], v[156:157]
    v_pk_add_f32 v[156:157], v[196:197], v[156:157] neg_lo:[0,1] neg_hi:[0,1]
    v_cvt_pk_bf16_f32 v10, v116, v117
    v_cvt_pk_bf16_f32 v30, v156, v157
    v_pk_fma_f32 v[198:199], v[118:119], v[192:193], v[200:201] op_sel_hi:[1,0,0] neg_lo:[0,0,1] neg_hi:[0,0,1]
    v_pk_fma_f32 v[158:159], v[158:159], v[194:195], v[202:203] op_sel_hi:[1,0,0] neg_lo:[0,0,1] neg_hi:[0,0,1]
    v_pk_add_f32 v[118:119], v[198:199], v[158:159]
    v_pk_add_f32 v[158:159], v[198:199], v[158:159] neg_lo:[0,1] neg_hi:[0,1]
    v_cvt_pk_bf16_f32 v11, v118, v119
    v_cvt_pk_bf16_f32 v31, v158, v159
    ds_write_b128 v104, v[8:11] offset:0
    ds_write_b128 v104, v[28:31] offset:5120
    v_pk_fma_f32 v[196:197], v[120:121], v[192:193], v[200:201] op_sel_hi:[1,0,0] neg_lo:[0,0,1] neg_hi:[0,0,1]
    v_pk_fma_f32 v[160:161], v[160:161], v[194:195], v[202:203] op_sel_hi:[1,0,0] neg_lo:[0,0,1] neg_hi:[0,0,1]
    v_pk_add_f32 v[120:121], v[196:197], v[160:161]
    v_pk_add_f32 v[160:161], v[196:197], v[160:161] neg_lo:[0,1] neg_hi:[0,1]
    v_cvt_pk_bf16_f32 v12, v120, v121
    v_cvt_pk_bf16_f32 v32, v160, v161
    v_pk_fma_f32 v[198:199], v[122:123], v[192:193], v[200:201] op_sel_hi:[1,0,0] neg_lo:[0,0,1] neg_hi:[0,0,1]
    v_pk_fma_f32 v[162:163], v[162:163], v[194:195], v[202:203] op_sel_hi:[1,0,0] neg_lo:[0,0,1] neg_hi:[0,0,1]
    v_pk_add_f32 v[122:123], v[198:199], v[162:163]
    v_pk_add_f32 v[162:163], v[198:199], v[162:163] neg_lo:[0,1] neg_hi:[0,1]
    v_cvt_pk_bf16_f32 v13, v122, v123
    v_cvt_pk_bf16_f32 v33, v162, v163
    v_pk_fma_f32 v[196:197], v[124:125], v[192:193], v[200:201] op_sel_hi:[1,0,0] neg_lo:[0,0,1] neg_hi:[0,0,1]
    v_pk_fma_f32 v[164:165], v[164:165], v[194:195], v[202:203] op_sel_hi:[1,0,0] neg_lo:[0,0,1] neg_hi:[0,0,1]
    v_pk_add_f32 v[124:125], v[196:197], v[164:165]
    v_pk_add_f32 v[164:165], v[196:197], v[164:165] neg_lo:[0,1] neg_hi:[0,1]
    v_cvt_pk_bf16_f32 v14, v124, v125
    v_cvt_pk_bf16_f32 v34, v164, v165
    v_pk_fma_f32 v[198:199], v[126:127], v[192:193], v[200:201] op_sel_hi:[1,0,0] neg_lo:[0,0,1] neg_hi:[0,0,1]
    v_pk_fma_f32 v[166:167], v[166:167], v[194:195], v[202:203] op_sel_hi:[1,0,0] neg_lo:[0,0,1] neg_hi:[0,0,1]
    v_pk_add_f32 v[126:127], v[198:199], v[166:167]
    v_pk_add_f32 v[166:167], v[198:199], v[166:167] neg_lo:[0,1] neg_hi:[0,1]
    v_cvt_pk_bf16_f32 v15, v126, v127
    v_cvt_pk_bf16_f32 v35, v166, v167
    ds_write_b128 v104, v[12:15] offset:256
    ds_write_b128 v104, v[32:35] offset:5376
    v_pk_fma_f32 v[196:197], v[128:129], v[192:193], v[200:201] op_sel_hi:[1,0,0] neg_lo:[0,0,1] neg_hi:[0,0,1]
    v_pk_fma_f32 v[168:169], v[168:169], v[194:195], v[202:203] op_sel_hi:[1,0,0] neg_lo:[0,0,1] neg_hi:[0,0,1]
    v_pk_add_f32 v[128:129], v[196:197], v[168:169]
    v_pk_add_f32 v[168:169], v[196:197], v[168:169] neg_lo:[0,1] neg_hi:[0,1]
    v_cvt_pk_bf16_f32 v16, v128, v129
    v_cvt_pk_bf16_f32 v36, v168, v169
    v_pk_fma_f32 v[198:199], v[130:131], v[192:193], v[200:201] op_sel_hi:[1,0,0] neg_lo:[0,0,1] neg_hi:[0,0,1]
    v_pk_fma_f32 v[170:171], v[170:171], v[194:195], v[202:203] op_sel_hi:[1,0,0] neg_lo:[0,0,1] neg_hi:[0,0,1]
    v_pk_add_f32 v[130:131], v[198:199], v[170:171]
    v_pk_add_f32 v[170:171], v[198:199], v[170:171] neg_lo:[0,1] neg_hi:[0,1]
    v_cvt_pk_bf16_f32 v17, v130, v131
    v_cvt_pk_bf16_f32 v37, v170, v171
    v_pk_fma_f32 v[196:197], v[132:133], v[192:193], v[200:201] op_sel_hi:[1,0,0] neg_lo:[0,0,1] neg_hi:[0,0,1]
    v_pk_fma_f32 v[172:173], v[172:173], v[194:195], v[202:203] op_sel_hi:[1,0,0] neg_lo:[0,0,1] neg_hi:[0,0,1]
    v_pk_add_f32 v[132:133], v[196:197], v[172:173]
    v_pk_add_f32 v[172:173], v[196:197], v[172:173] neg_lo:[0,1] neg_hi:[0,1]
    s_lshl_b32 s54, s4, 6
    s_add_u32 s54, s54, 25600
    s_waitcnt lgkmcnt(0)
    s_add_u32 s92, s92, 1
    s_mul_i32 s93, s92, 0x9E3779B1
    s_xor_b32 s93, s93, 0x5bd1e995
    s_waitcnt vmcnt(0)
    s_barrier
    s_cmp_lg_u32 s3, 0
    s_cbranch_scc1 nofl4
    s_mov_b32 s60, s6
    s_mov_b32 s61, s7
    s_mov_b32 s62, 524288
    s_mov_b32 s63, 0x00020000
    v_mov_b32 v246, s92
    v_mov_b32 v247, s93
    v_and_b32 v248, 63, v0
    v_lshlrev_b32 v248, 3, v248
    s_mov_b64 exec, 0xff
    buffer_store_dwordx2 v[246:247], v248, s[60:63], s54 offen sc1
    s_mov_b64 exec, -1
nofl4:
    v_cvt_pk_bf16_f32 v18, v132, v133
    v_cvt_pk_bf16_f32 v38, v172, v173
    v_pk_fma_f32 v[198:199], v[134:135], v[192:193], v[200:201] op_sel_hi:[1,0,0] neg_lo:[0,0,1] neg_hi:[0,0,1]
    v_pk_fma_f32 v[174:175], v[174:175], v[194:195], v[202:203] op_sel_hi:[1,0,0] neg_lo:[0,0,1] neg_hi:[0,0,1]
    v_pk_add_f32 v[134:135], v[198:199], v[174:175]
    v_pk_add_f32 v[174:175], v[198:199], v[174:175] neg_lo:[0,1] neg_hi:[0,1]
    v_cvt_pk_bf16_f32 v19, v134, v135
    v_cvt_pk_bf16_f32 v39, v174, v175
    ds_write_b128 v104, v[16:19] offset:512
    ds_write_b128 v104, v[36:39] offset:5632
    v_pk_fma_f32 v[196:197], v[136:137], v[192:193], v[200:201] op_sel_hi:[1,0,0] neg_lo:[0,0,1] neg_hi:[0,0,1]
    v_pk_fma_f32 v[176:177], v[176:177], v[194:195], v[202:203] op_sel_hi:[1,0,0] neg_lo:[0,0,1] neg_hi:[0,0,1]
    v_pk_add_f32 v[136:137], v[196:197], v[176:177]
    v_pk_add_f32 v[176:177], v[196:197], v[176:177] neg_lo:[0,1] neg_hi:[0,1]
    v_cvt_pk_bf16_f32 v20, v136, v137
    v_cvt_pk_bf16_f32 v40, v176, v177
    v_pk_fma_f32 v[198:199], v[138:139], v[192:193], v[200:201] op_sel_hi:[1,0,0] neg_lo:[0,0,1] neg_hi:[0,0,1]
    v_pk_fma_f32 v[178:179], v[178:179], v[194:195], v[202:203] op_sel_hi:[1,0,0] neg_lo:[0,0,1] neg_hi:[0,0,1]
    v_pk_add_f32 v[138:139], v[198:199], v[178:179]
    v_pk_add_f32 v[178:179], v[198:199], v[178:179] neg_lo:[0,1] neg_hi:[0,1]
    v_cvt_pk_bf16_f32 v21, v138, v139
    v_cvt_pk_bf16_f32 v41, v178, v179
    v_pk_fma_f32 v[196:197], v[140:141], v[192:193], v[200:201] op_sel_hi:[1,0,0] neg_lo:[0,0,1] neg_hi:[0,0,1]
    v_pk_fma_f32 v[180:181], v[180:181], v[194:195], v[202:203] op_sel_hi:[1,0,0] neg_lo:[0,0,1] neg_hi:[0,0,1]
    v_pk_add_f32 v[140:141], v[196:197], v[180:181]
    v_pk_add_f32 v[180:181], v[196:197], v[180:181] neg_lo:[0,1] neg_hi:[0,1]
    v_cvt_pk_bf16_f32 v22, v140, v141
    v_cvt_pk_bf16_f32 v42, v180, v181
    v_pk_fma_f32 v[198:199], v[142:143], v[192:193], v[200:201] op_sel_hi:[1,0,0] neg_lo:[0,0,1] neg_hi:[0,0,1]
    v_pk_fma_f32 v[182:183], v[182:183], v[194:195], v[202:203] op_sel_hi:[1,0,0] neg_lo:[0,0,1] neg_hi:[0,0,1]
    v_pk_add_f32 v[142:143], v[198:199], v[182:183]
    v_pk_add_f32 v[182:183], v[198:199], v[182:183] neg_lo:[0,1] neg_hi:[0,1]
    v_cvt_pk_bf16_f32 v23, v142, v143
    v_cvt_pk_bf16_f32 v43, v182, v183
    ds_write_b128 v104, v[20:23] offset:768
    ds_write_b128 v104, v[40:43] offset:5888
    v_pk_fma_f32 v[196:197], v[144:145], v[192:193], v[200:201] op_sel_hi:[1,0,0] neg_lo:[0,0,1] neg_hi:[0,0,1]
    v_pk_fma_f32 v[184:185], v[184:185], v[194:195], v[202:203] op_sel_hi:[1,0,0] neg_lo:[0,0,1] neg_hi:[0,0,1]
    v_pk_add_f32 v[144:145], v[196:197], v[184:185]
    v_pk_add_f32 v[184:185], v[196:197], v[184:185] neg_lo:[0,1] neg_hi:[0,1]
    v_cvt_pk_bf16_f32 v24, v144, v145
    v_cvt_pk_bf16_f32 v44, v184, v185
    v_pk_fma_f32 v[198:199], v[146:147], v[192:193], v[200:201] op_sel_hi:[1,0,0] neg_lo:[0,0,1] neg_hi:[0,0,1]
    v_pk_fma_f32 v[186:187], v[186:187], v[194:195], v[202:203] op_sel_hi:[1,0,0] neg_lo:[0,0,1] neg_hi:[0,0,1]
    v_pk_add_f32 v[146:147], v[198:199], v[186:187]
    v_pk_add_f32 v[186:187], v[198:199], v[186:187] neg_lo:[0,1] neg_hi:[0,1]
    v_cvt_pk_bf16_f32 v25, v146, v147
    v_cvt_pk_bf16_f32 v45, v186, v187
    v_pk_fma_f32 v[196:197], v[148:149], v[192:193], v[200:201] op_sel_hi:[1,0,0] neg_lo:[0,0,1] neg_hi:[0,0,1]
    v_pk_fma_f32 v[188:189], v[188:189], v[194:195], v[202:203] op_sel_hi:[1,0,0] neg_lo:[0,0,1] neg_hi:[0,0,1]
    v_pk_add_f32 v[148:149], v[196:197], v[188:189]
    v_pk_add_f32 v[188:189], v[196:197], v[188:189] neg_lo:[0,1] neg_hi:[0,1]
    v_cvt_pk_bf16_f32 v26, v148, v149
    v_cvt_pk_bf16_f32 v46, v188, v189
    v_pk_fma_f32 v[198:199], v[150:151], v[192:193], v[200:201] op_sel_hi:[1,0,0] neg_lo:[0,0,1] neg_hi:[0,0,1]
    v_pk_fma_f32 v[190:191], v[190:191], v[194:195], v[202:203] op_sel_hi:[1,0,0] neg_lo:[0,0,1] neg_hi:[0,0,1]
    v_pk_add_f32 v[150:151], v[198:199], v[190:191]
    v_pk_add_f32 v[190:191], v[198:199], v[190:191] neg_lo:[0,1] neg_hi:[0,1]
    v_cvt_pk_bf16_f32 v27, v150, v151
    v_cvt_pk_bf16_f32 v47, v190, v191
    ds_write_b128 v104, v[24:27] offset:1024
    ds_write_b128 v104, v[44:47] offset:6144
    s_mul_i32 s44, s32, 10496
    s_mul_i32 s46, s3, 6144
    s_add_u32 s46, s46, 81920
    v_lshlrev_b32 v180, 4, v1
    v_add_u32 v181, s46, v180
    v_mov_b32 v4, 5152
    v_min_u32 v107, v107, v4
    v_add_u32 v107, s46, v107
    v_min_u32 v108, v108, v4
    v_add_u32 v108, s46, v108
    v_min_u32 v109, v109, v4
    v_add_u32 v109, s46, v109
    s_mov_b32 s45, 0
    s_waitcnt lgkmcnt(0)
k1_fft_loop:
    ds_read_b64_tr_b16 v[112:113], v105 offset:0
    ds_read_b64_tr_b16 v[114:115], v106 offset:0
    ds_read_b64_tr_b16 v[116:117], v105 offset:32
    ds_read_b64_tr_b16 v[118:119], v106 offset:32
    ds_read_b64_tr_b16 v[120:121], v105 offset:1280
    ds_read_b64_tr_b16 v[122:123], v106 offset:1280
    ds_read_b64_tr_b16 v[124:125], v105 offset:1312
    ds_read_b64_tr_b16 v[126:127], v106 offset:1312
    ds_read_b64_tr_b16 v[128:129], v105 offset:2560
    ds_read_b64_tr_b16 v[130:131], v106 offset:2560
    ds_read_b64_tr_b16 v[132:133], v105 offset:2592
    ds_read_b64_tr_b16 v[134:135], v106 offset:2592
    ds_read_b64_tr_b16 v[136:137], v105 offset:3840
    ds_read_b64_tr_b16 v[138:139], v106 offset:3840
    ds_read_b64_tr_b16 v[140:141], v105 offset:3872
    ds_read_b64_tr_b16 v[142:143], v106 offset:3872
    v_add_u32 v105, 5120, v105
    v_add_u32 v106, 5120, v106
    s_waitcnt lgkmcnt(12)
    v_mfma_f32_16x16x32_bf16 v[8:11], v[112:115], v[48:51], 0
    v_mfma_f32_16x16x32_bf16 v[12:15], v[112:115], v[52:55], 0
    v_mfma_f32_16x16x32_bf16 v[16:19], v[116:119], v[48:51], 0
    v_mfma_f32_16x16x32_bf16 v[20:23], v[116:119], v[52:55], 0
    s_waitcnt lgkmcnt(8)
    v_mfma_f32_16x16x32_bf16 v[24:27], v[120:123], v[48:51], 0
    v_mfma_f32_16x16x32_bf16 v[28:31], v[120:123], v[52:55], 0
    v_mfma_f32_16x16x32_bf16 v[32:35], v[124:127], v[48:51], 0
    v_mfma_f32_16x16x32_bf16 v[36:39], v[124:127], v[52:55], 0
    v_pk_mul_f32 v[144:145], v[8:9], v[64:65]
    v_pk_mul_f32 v[8:9], v[8:9], v[56:57]
    v_pk_fma_f32 v[8:9], v[12:13], v[64:65], v[8:9]
    v_pk_fma_f32 v[12:13], v[12:13], v[56:57], v[144:145] neg_lo:[0,0,1] neg_hi:[0,0,1]
    v_pk_mul_f32 v[146:147], v[10:11], v[66:67]
    v_pk_mul_f32 v[10:11], v[10:11], v[58:59]
    v_pk_fma_f32 v[10:11], v[14:15], v[66:67], v[10:11]
    v_pk_fma_f32 v[14:15], v[14:15], v[58:59], v[146:147] neg_lo:[0,0,1] neg_hi:[0,0,1]
    v_cvt_pk_bf16_f32 v112, v8, v12
    v_cvt_pk_bf16_f32 v113, v9, v13
    v_cvt_pk_bf16_f32 v114, v10, v14
    v_cvt_pk_bf16_f32 v115, v11, v15
    v_pk_mul_f32 v[144:145], v[16:17], v[68:69]
    v_pk_mul_f32 v[16:17], v[16:17], v[60:61]
    v_pk_fma_f32 v[16:17], v[20:21], v[68:69], v[16:17]
    v_pk_fma_f32 v[20:21], v[20:21], v[60:61], v[144:145] neg_lo:[0,0,1] neg_hi:[0,0,1]
    v_pk_mul_f32 v[146:147], v[18:19], v[70:71]
    v_pk_mul_f32 v[18:19], v[18:19], v[62:63]
    v_pk_fma_f32 v[18:19], v[22:23], v[70:71], v[18:19]
    v_pk_fma_f32 v[22:23], v[22:23], v[62:63], v[146:147] neg_lo:[0,0,1] neg_hi:[0,0,1]
    v_cvt_pk_bf16_f32 v116, v16, v20
    v_cvt_pk_bf16_f32 v117, v17, v21
    v_cvt_pk_bf16_f32 v118, v18, v22
    v_cvt_pk_bf16_f32 v119, v19, v23
    v_mfma_f32_16x16x32_bf16 v[8:11], v[72:75], v[112:115], 0
    v_mfma_f32_16x16x32_bf16 v[12:15], v[76:79], v[112:115], 0
    v_mfma_f32_16x16x32_bf16 v[16:19], v[88:91], v[112:115], 0
    v_mfma_f32_16x16x32_bf16 v[20:23], v[92:95], v[112:115], 0
    v_mfma_f32_16x16x32_bf16 v[8:11], v[80:83], v[116:119], v[8:11]
    v_mfma_f32_16x16x32_bf16 v[12:15], v[84:87], v[116:119], v[12:15]
    v_mfma_f32_16x16x32_bf16 v[16:19], v[96:99], v[116:119], v[16:19]
    v_mfma_f32_16x16x32_bf16 v[20:23], v[100:103], v[116:119], v[20:23]
    v_pk_mul_f32 v[144:145], v[24:25], v[64:65]
    v_pk_mul_f32 v[24:25], v[24:25], v[56:57]
    v_pk_fma_f32 v[24:25], v[28:29], v[64:65], v[24:25]
    v_pk_fma_f32 v[28:29], v[28:29], v[56:57], v[144:145] neg_lo:[0,0,1] neg_hi:[0,0,1]
    v_pk_mul_f32 v[146:147], v[26:27], v[66:67]
    v_pk_mul_f32 v[26:27], v[26:27], v[58:59]
    v_pk_fma_f32 v[26:27], v[30:31], v[66:67], v[26:27]
    v_pk_fma_f32 v[30:31], v[30:31], v[58:59], v[146:147] neg_lo:[0,0,1] neg_hi:[0,0,1]
    v_cvt_pk_bf16_f32 v120, v24, v28
    v_cvt_pk_bf16_f32 v121, v25, v29
    v_cvt_pk_bf16_f32 v122, v26, v30
    v_cvt_pk_bf16_f32 v123, v27, v31
    v_pk_mul_f32 v[144:145], v[32:33], v[68:69]
    v_pk_mul_f32 v[32:33], v[32:33], v[60:61]
    v_pk_fma_f32 v[32:33], v[36:37], v[68:69], v[32:33]
    v_pk_fma_f32 v[36:37], v[36:37], v[60:61], v[144:145] neg_lo:[0,0,1] neg_hi:[0,0,1]
    v_pk_mul_f32 v[146:147], v[34:35], v[70:71]
    v_pk_mul_f32 v[34:35], v[34:35], v[62:63]
    v_pk_fma_f32 v[34:35], v[38:39], v[70:71], v[34:35]
    v_pk_fma_f32 v[38:39], v[38:39], v[62:63], v[146:147] neg_lo:[0,0,1] neg_hi:[0,0,1]
    v_cvt_pk_bf16_f32 v124, v32, v36
    v_cvt_pk_bf16_f32 v125, v33, v37
    v_cvt_pk_bf16_f32 v126, v34, v38
    v_cvt_pk_bf16_f32 v127, v35, v39
    v_mfma_f32_16x16x32_bf16 v[24:27], v[72:75], v[120:123], 0
    v_mfma_f32_16x16x32_bf16 v[28:31], v[76:79], v[120:123], 0
    v_mfma_f32_16x16x32_bf16 v[32:35], v[88:91], v[120:123], 0
    v_mfma_f32_16x16x32_bf16 v[36:39], v[92:95], v[120:123], 0
    v_mfma_f32_16x16x32_bf16 v[24:27], v[80:83], v[124:127], v[24:27]
    v_mfma_f32_16x16x32_bf16 v[28:31], v[84:87], v[124:127], v[28:31]
    v_mfma_f32_16x16x32_bf16 v[32:35], v[96:99], v[124:127], v[32:35]
    v_mfma_f32_16x16x32_bf16 v[36:39], v[100:103], v[124:127], v[36:39]
    v_cvt_pk_bf16_f32 v148, v8, v12
    v_cvt_pk_bf16_f32 v152, v9, v13
    v_cvt_pk_bf16_f32 v156, v10, v14
    v_cvt_pk_bf16_f32 v160, v11, v15
    v_cvt_pk_bf16_f32 v164, v16, -v20
    v_cvt_pk_bf16_f32 v168, v17, -v21
    v_cvt_pk_bf16_f32 v172, v18, -v22
    v_cvt_pk_bf16_f32 v176, v19, -v23
    s_waitcnt lgkmcnt(4)
    v_mfma_f32_16x16x32_bf16 v[8:11], v[128:131], v[48:51], 0
    v_mfma_f32_16x16x32_bf16 v[12:15], v[128:131], v[52:55], 0
    v_mfma_f32_16x16x32_bf16 v[16:19], v[132:135], v[48:51], 0
    v_mfma_f32_16x16x32_bf16 v[20:23], v[132:135], v[52:55], 0
    v_cvt_pk_bf16_f32 v149, v24, v28
    v_cvt_pk_bf16_f32 v153, v25, v29
    v_cvt_pk_bf16_f32 v157, v26, v30
    v_cvt_pk_bf16_f32 v161, v27, v31
    v_cvt_pk_bf16_f32 v165, v32, -v36
    v_cvt_pk_bf16_f32 v169, v33, -v37
    v_cvt_pk_bf16_f32 v173, v34, -v38
    v_cvt_pk_bf16_f32 v177, v35, -v39
    s_waitcnt lgkmcnt(0)
    v_mfma_f32_16x16x32_bf16 v[24:27], v[136:139], v[48:51], 0
    v_mfma_f32_16x16x32_bf16 v[28:31], v[136:139], v[52:55], 0
    v_mfma_f32_16x16x32_bf16 v[32:35], v[140:143], v[48:51], 0
    v_mfma_f32_16x16x32_bf16 v[36:39], v[140:143], v[52:55], 0
    v_pk_mul_f32 v[144:145], v[8:9], v[64:65]
    v_pk_mul_f32 v[8:9], v[8:9], v[56:57]
    v_pk_fma_f32 v[8:9], v[12:13], v[64:65], v[8:9]
    v_pk_fma_f32 v[12:13], v[12:13], v[56:57], v[144:145] neg_lo:[0,0,1] neg_hi:[0,0,1]
    v_pk_mul_f32 v[146:147], v[10:11], v[66:67]
    v_pk_mul_f32 v[10:11], v[10:11], v[58:59]
    v_pk_fma_f32 v[10:11], v[14:15], v[66:67], v[10:11]
    v_pk_fma_f32 v[14:15], v[14:15], v[58:59], v[146:147] neg_lo:[0,0,1] neg_hi:[0,0,1]
    v_cvt_pk_bf16_f32 v128, v8, v12
    v_cvt_pk_bf16_f32 v129, v9, v13
    v_cvt_pk_bf16_f32 v130, v10, v14
    v_cvt_pk_bf16_f32 v131, v11, v15
    v_pk_mul_f32 v[144:145], v[16:17], v[68:69]
    v_pk_mul_f32 v[16:17], v[16:17], v[60:61]
    v_pk_fma_f32 v[16:17], v[20:21], v[68:69], v[16:17]
    v_pk_fma_f32 v[20:21], v[20:21], v[60:61], v[144:145] neg_lo:[0,0,1] neg_hi:[0,0,1]
    v_pk_mul_f32 v[146:147], v[18:19], v[70:71]
    v_pk_mul_f32 v[18:19], v[18:19], v[62:63]
    v_pk_fma_f32 v[18:19], v[22:23], v[70:71], v[18:19]
    v_pk_fma_f32 v[22:23], v[22:23], v[62:63], v[146:147] neg_lo:[0,0,1] neg_hi:[0,0,1]
    v_cvt_pk_bf16_f32 v132, v16, v20
    v_cvt_pk_bf16_f32 v133, v17, v21
    v_cvt_pk_bf16_f32 v134, v18, v22
    v_cvt_pk_bf16_f32 v135, v19, v23
    v_mfma_f32_16x16x32_bf16 v[8:11], v[72:75], v[128:131], 0
    v_mfma_f32_16x16x32_bf16 v[12:15], v[76:79], v[128:131], 0
    v_mfma_f32_16x16x32_bf16 v[16:19], v[88:91], v[128:131], 0
    v_mfma_f32_16x16x32_bf16 v[20:23], v[92:95], v[128:131], 0
    v_mfma_f32_16x16x32_bf16 v[8:11], v[80:83], v[132:135], v[8:11]
    v_mfma_f32_16x16x32_bf16 v[12:15], v[84:87], v[132:135], v[12:15]
    v_mfma_f32_16x16x32_bf16 v[16:19], v[96:99], v[132:135], v[16:19]
    v_mfma_f32_16x16x32_bf16 v[20:23], v[100:103], v[132:135], v[20:23]
    v_pk_mul_f32 v[144:145], v[24:25], v[64:65]
    v_pk_mul_f32 v[24:25], v[24:25], v[56:57]
    v_pk_fma_f32 v[24:25], v[28:29], v[64:65], v[24:25]
    v_pk_fma_f32 v[28:29], v[28:29], v[56:57], v[144:145] neg_lo:[0,0,1] neg_hi:[0,0,1]
    v_pk_mul_f32 v[146:147], v[26:27], v[66:67]
    v_pk_mul_f32 v[26:27], v[26:27], v[58:59]
    v_pk_fma_f32 v[26:27], v[30:31], v[66:67], v[26:27]
    v_pk_fma_f32 v[30:31], v[30:31], v[58:59], v[146:147] neg_lo:[0,0,1] neg_hi:[0,0,1]
    v_cvt_pk_bf16_f32 v136, v24, v28
    v_cvt_pk_bf16_f32 v137, v25, v29
    v_cvt_pk_bf16_f32 v138, v26, v30
    v_cvt_pk_bf16_f32 v139, v27, v31
    v_pk_mul_f32 v[144:145], v[32:33], v[68:69]
    v_pk_mul_f32 v[32:33], v[32:33], v[60:61]
    v_pk_fma_f32 v[32:33], v[36:37], v[68:69], v[32:33]
    v_pk_fma_f32 v[36:37], v[36:37], v[60:61], v[144:145] neg_lo:[0,0,1] neg_hi:[0,0,1]
    v_pk_mul_f32 v[146:147], v[34:35], v[70:71]
    v_pk_mul_f32 v[34:35], v[34:35], v[62:63]
    v_pk_fma_f32 v[34:35], v[38:39], v[70:71], v[34:35]
    v_pk_fma_f32 v[38:39], v[38:39], v[62:63], v[146:147] neg_lo:[0,0,1] neg_hi:[0,0,1]
    v_cvt_pk_bf16_f32 v140, v32, v36
    v_cvt_pk_bf16_f32 v141, v33, v37
    v_cvt_pk_bf16_f32 v142, v34, v38
    v_cvt_pk_bf16_f32 v143, v35, v39
    v_mfma_f32_16x16x32_bf16 v[24:27], v[72:75], v[136:139], 0
    v_mfma_f32_16x16x32_bf16 v[28:31], v[76:79], v[136:139], 0
    v_mfma_f32_16x16x32_bf16 v[32:35], v[88:91], v[136:139], 0
    v_mfma_f32_16x16x32_bf16 v[36:39], v[92:95], v[136:139], 0
    v_mfma_f32_16x16x32_bf16 v[24:27], v[80:83], v[140:143], v[24:27]
    v_mfma_f32_16x16x32_bf16 v[28:31], v[84:87], v[140:143], v[28:31]
    v_mfma_f32_16x16x32_bf16 v[32:35], v[96:99], v[140:143], v[32:35]
    v_mfma_f32_16x16x32_bf16 v[36:39], v[100:103], v[140:143], v[36:39]
    v_cvt_pk_bf16_f32 v150, v8, v12
    v_cvt_pk_bf16_f32 v154, v9, v13
    v_cvt_pk_bf16_f32 v158, v10, v14
    v_cvt_pk_bf16_f32 v162, v11, v15
    v_cvt_pk_bf16_f32 v166, v16, -v20
    v_cvt_pk_bf16_f32 v170, v17, -v21
    v_cvt_pk_bf16_f32 v174, v18, -v22
    v_cvt_pk_bf16_f32 v178, v19, -v23
    v_cvt_pk_bf16_f32 v151, v24, v28
    v_cvt_pk_bf16_f32 v155, v25, v29
    v_cvt_pk_bf16_f32 v159, v26, v30
    v_cvt_pk_bf16_f32 v163, v27, v31
    v_cvt_pk_bf16_f32 v167, v32, -v36
    v_cvt_pk_bf16_f32 v171, v33, -v37
    v_cvt_pk_bf16_f32 v175, v34, -v38
    v_cvt_pk_bf16_f32 v179, v35, -v39
    ds_write_b128 v107, v[148:151] offset:0
    ds_write_b128 v107, v[152:155] offset:320
    ds_write_b128 v107, v[156:159] offset:640
    ds_write_b128 v107, v[160:163] offset:960
    ds_write_b128 v109, v[164:167] offset:960
    ds_write_b128 v108, v[168:171] offset:640
    ds_write_b128 v108, v[172:175] offset:320
    ds_write_b128 v108, v[176:179] offset:0
    s_waitcnt lgkmcnt(0)
    ds_read_b128 v[148:151], v181 offset:0
    ds_read_b128 v[152:155], v181 offset:1024
    ds_read_b128 v[156:159], v181 offset:2048
    ds_read_b128 v[160:163], v181 offset:3072
    ds_read_b128 v[164:167], v181 offset:4096
    ds_read_b128 v[168:171], v181 offset:5120
    s_add_u32 s47, s44, 4096
    s_waitcnt lgkmcnt(5)
    buffer_store_dwordx4 v[148:151], v180, s[24:27], s44 offen offset:0 sc1
    s_waitcnt lgkmcnt(4)
    buffer_store_dwordx4 v[152:155], v180, s[24:27], s44 offen offset:1024 sc1
    s_waitcnt lgkmcnt(3)
    buffer_store_dwordx4 v[156:159], v180, s[24:27], s44 offen offset:2048 sc1
    s_waitcnt lgkmcnt(2)
    buffer_store_dwordx4 v[160:163], v180, s[24:27], s44 offen offset:3072 sc1
    s_waitcnt lgkmcnt(1)
    buffer_store_dwordx4 v[164:167], v180, s[24:27], s47 offen offset:0 sc1
    s_waitcnt lgkmcnt(0)
    s_mov_b64 exec, 15
    buffer_store_dwordx4 v[168:171], v180, s[24:27], s47 offen offset:1024 sc1
    s_mov_b64 exec, -1
    s_add_u32 s44, s44, 5248
    s_add_u32 s45, s45, 1
    s_cmp_lt_u32 s45, 2
    s_cbranch_scc1 k1_fft_loop
    s_lshl_b32 s58, s4, 6
    s_add_u32 s58, s58, 15360
    s_waitcnt vmcnt(0)
    s_barrier
    s_cmp_lg_u32 s3, 0
    s_cbranch_scc1 nofl5
    s_mov_b32 s60, s6
    s_mov_b32 s61, s7
    s_mov_b32 s62, 524288
    s_mov_b32 s63, 0x00020000
    v_mov_b32 v246, s92
    v_mov_b32 v247, s93
    v_and_b32 v248, 63, v0
    v_lshlrev_b32 v248, 3, v248
    s_mov_b64 exec, 0xff
    buffer_store_dwordx2 v[246:247], v248, s[60:63], s58 offen sc1
    s_mov_b64 exec, -1
nofl5:
    s_mov_b32 s58, 0
    s_cmp_lt_u32 s3, 4
    s_cbranch_scc1 k2_comp
    s_branch k2_loader
k2_fft:
    s_mov_b32 s10, 10496
    s_bfe_u32 s24, s2, 0x10003
    s_and_b32 s25, s2, 7
    s_mul_i32 s25, s25, 5
    s_lshr_b32 s26, s2, 4
    s_add_u32 s25, s25, s26
    s_and_b32 s26, s2, 1
    s_cmp_ge_u32 s2, 80
    s_cselect_b32 s24, s26, s24
    s_cselect_b32 s25, 40, s25
    v_and_b32 v1, 63, v0
    v_lshrrev_b32 v2, 3, v1
    v_bfe_u32 v3, v0, 4, 3
    v_and_b32 v4, 7, v0
    v_xor_b32 v3, v3, v4
    v_lshlrev_b32 v3, 4, v3
    v_mad_u32_u24 v5, v2, s10, v3
    s_lshl_b32 s28, s25, 7
    s_lshl_b32 s27, s3, 4
    s_add_u32 s27, s27, s24
    s_mul_i32 s27, s27, 5248
    s_add_u32 s27, s27, s28
    s_lshl_b32 s29, s3, 10
    s_add_u32 s12, s6, 8388608
    s_addc_u32 s13, s7, 0
    s_mov_b32 s14, 2686976
    s_mov_b32 s15, 0x00020000
    s_mov_b32 s11, 10368
    v_mad_u32_u24 v6, v2, s11, v3
    s_mul_i32 s37, s3, 82944
    s_mul_i32 s38, s24, 5136
    s_add_u32 s37, s37, s38
    s_add_u32 s37, s37, s28
    s_add_u32 s16, s6, 12582912
    s_addc_u32 s17, s7, 0
    s_mov_b32 s18, 2654336
    s_mov_b32 s19, 0x00020000
    s_lshl_b32 s42, s25, 1
    s_add_u32 s42, s42, s24
    s_lshl_b32 s42, s42, 15
    s_add_u32 s42, s42, s29
    v_lshl_add_u32 v7, v2, 7, v3
    s_add_u32 s20, s6, 16777216
    s_addc_u32 s21, s7, 0
    s_mov_b32 s22, 2686976
    s_mov_b32 s23, 0x00020000
    v_and_b32 v8, 31, v0
    v_bfe_u32 v9, v0, 5, 1
    s_add_u32 m0, s29, 0
    s_nop 0
    buffer_load_dwordx4 v5, s[12:15], s27 offen sc1 lds
    s_add_u32 m0, s29, 8192
    s_add_u32 s27, s27, 671744
    buffer_load_dwordx4 v5, s[12:15], s27 offen sc1 lds
    s_add_u32 m0, s29, 16384
    s_add_u32 s27, s27, 671744
    buffer_load_dwordx4 v5, s[12:15], s27 offen sc1 lds
    s_add_u32 m0, s29, 24576
    s_add_u32 s27, s27, 671744
    buffer_load_dwordx4 v5, s[12:15], s27 offen sc1 lds
    v_lshlrev_b32 v244, 4, v1
    v_add_u32 v244, 65536, v244
    v_add_u32 v4, s29, v244
    v_bfe_u32 v2, v0, 1, 3
    v_xor_b32 v2, s3, v2
    v_lshlrev_b32 v2, 4, v2
    v_lshl_add_u32 v10, v1, 7, v2
    v_and_b32 v2, 1, v0
    v_lshlrev_b32 v2, 2, v2
    v_xor_b32 v2, s3, v2
    v_lshlrev_b32 v2, 4, v2
    v_lshl_add_u32 v11, v8, 10, v2
    v_lshl_add_u32 v11, v9, 7, v11
    s_mov_b32 s41, 0xffff0000
    ds_read_b128 v[12:15], v244 offset:0
    ds_read_b128 v[16:19], v244 offset:1024
    ds_read_b128 v[20:23], v244 offset:2048
    ds_read_b128 v[24:27], v244 offset:3072
    ds_read_b128 v[28:31], v244 offset:4096
    ds_read_b128 v[32:35], v244 offset:5120
    ds_read_b128 v[36:39], v244 offset:6144
    ds_read_b128 v[40:43], v244 offset:7168
    ds_read_b128 v[108:111], v244 offset:8192
    ds_read_b128 v[124:127], v244 offset:12288
    ds_read_b128 v[112:115], v244 offset:9216
    ds_read_b128 v[128:131], v244 offset:13312
    ds_read_b128 v[116:119], v244 offset:10240
    ds_read_b128 v[132:135], v244 offset:14336
    ds_read_b128 v[120:123], v244 offset:11264
    ds_read_b128 v[136:139], v244 offset:15360
    ds_read_b128 v[44:47], v244 offset:32768
    ds_read_b128 v[48:51], v244 offset:33792
    ds_read_b128 v[52:55], v244 offset:34816
    ds_read_b128 v[56:59], v244 offset:35840
    ds_read_b128 v[60:63], v244 offset:36864
    ds_read_b128 v[64:67], v244 offset:37888
    ds_read_b128 v[68:71], v244 offset:38912
    ds_read_b128 v[72:75], v244 offset:39936
    ds_read_b128 v[76:79], v244 offset:16384
    ds_read_b128 v[80:83], v244 offset:17408
    ds_read_b128 v[84:87], v244 offset:18432
    ds_read_b128 v[88:91], v244 offset:19456
    ds_read_b128 v[92:95], v244 offset:20480
    ds_read_b128 v[96:99], v244 offset:21504
    ds_read_b128 v[100:103], v244 offset:22528
    ds_read_b128 v[104:107], v244 offset:23552
    s_waitcnt vmcnt(0) lgkmcnt(0)
    s_barrier
    ds_read_b128 v[140:143], v10 offset:0
    ds_read_b128 v[144:147], v10 offset:8192
    ds_read_b128 v[148:151], v10 offset:16384
    ds_read_b128 v[152:155], v10 offset:24576
    s_waitcnt lgkmcnt(3)
    v_mfma_f32_32x32x16_bf16 v[172:187], v[140:143], v[12:15], 0
    v_mfma_f32_32x32x16_bf16 v[188:203], v[140:143], v[28:31], 0
    s_waitcnt lgkmcnt(2)
    v_mfma_f32_32x32x16_bf16 v[172:187], v[144:147], v[16:19], v[172:187]
    v_mfma_f32_32x32x16_bf16 v[188:203], v[144:147], v[32:35], v[188:203]
    s_waitcnt lgkmcnt(1)
    v_mfma_f32_32x32x16_bf16 v[172:187], v[148:151], v[20:23], v[172:187]
    v_mfma_f32_32x32x16_bf16 v[188:203], v[148:151], v[36:39], v[188:203]
    s_waitcnt lgkmcnt(0)
    v_mfma_f32_32x32x16_bf16 v[172:187], v[152:155], v[24:27], v[172:187]
    v_mfma_f32_32x32x16_bf16 v[188:203], v[152:155], v[40:43], v[188:203]
    s_cmp_lt_u32 s3, 6
    s_nop 8
    s_cbranch_scc1 k2_nowd
    s_mov_b32 s60, s6
    s_mov_b32 s61, s7
    s_mov_b32 s62, 524288
    s_mov_b32 s63, 0x00020000
    s_mov_b32 s58, 1024
    v_and_b32 v164, 63, v0
    v_lshlrev_b32 v164, 6, v164
    v_add_u32 v165, 4096, v164
    v_add_u32 v166, 8192, v164
    v_add_u32 v167, 12288, v164
    s_mov_b32 s59, 0
    s_mov_b32 s56, 0xffffffff
    s_mov_b32 s57, 0x0
    s_mov_b64 s[68:69], -1
    s_mov_b64 s[66:67], -1
    s_mov_b64 s[64:65], -1
poll6:
    s_mov_b64 exec, s[68:69]
    s_cbranch_execz poll6s0
    buffer_load_dwordx2 v[156:157], v164, s[60:63], s58 offen sc1
poll6s0:
    s_mov_b64 exec, s[66:67]
    s_cbranch_execz poll6s1
    buffer_load_dwordx2 v[158:159], v165, s[60:63], s58 offen sc1
poll6s1:
    s_mov_b64 exec, s[64:65]
    s_cbranch_execz poll6s2
    buffer_load_dwordx2 v[160:161], v166, s[60:63], s58 offen sc1
poll6s2:
    s_mov_b64 exec, s[56:57]
    s_cbranch_execz poll6s3
    buffer_load_dwordx2 v[162:163], v167, s[60:63], s58 offen sc1
poll6s3:
    s_waitcnt vmcnt(0)
    s_mov_b64 exec, s[68:69]
    v_cmp_ne_u64 s[68:69], s[92:93], v[156:157]
    s_mov_b64 exec, s[66:67]
    v_cmp_ne_u64 s[66:67], s[92:93], v[158:159]
    s_mov_b64 exec, s[64:65]
    v_cmp_ne_u64 s[64:65], s[92:93], v[160:161]
    s_mov_b64 exec, s[56:57]
    v_cmp_ne_u64 s[56:57], s[92:93], v[162:163]
    s_mov_b64 vcc, s[68:69]
    s_or_b64 vcc, vcc, s[66:67]
    s_or_b64 vcc, vcc, s[64:65]
    s_or_b64 vcc, vcc, s[56:57]
    s_cbranch_vccz poll6d
    s_add_u32 s59, s59, 1
    s_cmp_ge_u32 s59, 0x8000
    s_cbranch_scc1 poll6d
    s_sleep 2
    s_branch poll6
poll6d:
    s_mov_b64 exec, -1
    s_sub_u32 s37, s37, 497664
    s_sub_u32 s44, s29, 6144
    s_add_u32 m0, s44, 32768
    s_nop 0
    buffer_load_dwordx4 v6, s[16:19], s37 offen sc1 lds
    s_add_u32 m0, s44, 34816
    s_add_u32 s37, s37, 165888
    buffer_load_dwordx4 v6, s[16:19], s37 offen sc1 lds
    s_add_u32 m0, s44, 36864
    s_add_u32 s37, s37, 165888
    buffer_load_dwordx4 v6, s[16:19], s37 offen sc1 lds
    s_add_u32 m0, s44, 38912
    s_add_u32 s37, s37, 165888
    buffer_load_dwordx4 v6, s[16:19], s37 offen sc1 lds
    s_add_u32 m0, s44, 40960
    s_add_u32 s37, s37, 165888
    buffer_load_dwordx4 v6, s[16:19], s37 offen sc1 lds
    s_add_u32 m0, s44, 43008
    s_add_u32 s37, s37, 165888
    buffer_load_dwordx4 v6, s[16:19], s37 offen sc1 lds
    s_add_u32 m0, s44, 45056
    s_add_u32 s37, s37, 165888
    buffer_load_dwordx4 v6, s[16:19], s37 offen sc1 lds
    s_add_u32 m0, s44, 47104
    s_add_u32 s37, s37, 165888
    buffer_load_dwordx4 v6, s[16:19], s37 offen sc1 lds
    s_add_u32 m0, s44, 49152
    s_add_u32 s37, s37, 165888
    buffer_load_dwordx4 v6, s[16:19], s37 offen sc1 lds
    s_add_u32 m0, s44, 51200
    s_add_u32 s37, s37, 165888
    buffer_load_dwordx4 v6, s[16:19], s37 offen sc1 lds
    s_add_u32 m0, s44, 53248
    s_add_u32 s37, s37, 165888
    buffer_load_dwordx4 v6, s[16:19], s37 offen sc1 lds
    s_add_u32 m0, s44, 55296
    s_add_u32 s37, s37, 165888
    buffer_load_dwordx4 v6, s[16:19], s37 offen sc1 lds
    s_add_u32 m0, s44, 57344
    s_add_u32 s37, s37, 165888
    buffer_load_dwordx4 v6, s[16:19], s37 offen sc1 lds
    s_add_u32 m0, s44, 59392
    s_add_u32 s37, s37, 165888
    buffer_load_dwordx4 v6, s[16:19], s37 offen sc1 lds
    s_add_u32 m0, s44, 61440
    s_add_u32 s37, s37, 165888
    buffer_load_dwordx4 v6, s[16:19], s37 offen sc1 lds
    s_add_u32 m0, s44, 63488
    s_add_u32 s37, s37, 165888
    buffer_load_dwordx4 v6, s[16:19], s37 offen sc1 lds
k2_nowd:
    v_mul_f32 v236, v172, v108
    v_mul_f32 v237, v173, v109
    v_mul_f32 v238, v174, v110
    v_mul_f32 v239, v175, v111
    v_mul_f32 v172, v172, v124
    v_mul_f32 v173, v173, v125
    v_mul_f32 v174, v174, v126
    v_mul_f32 v175, v175, v127
    v_fmac_f32 v236, v188, v124
    v_fmac_f32 v237, v189, v125
    v_fmac_f32 v238, v190, v126
    v_fmac_f32 v239, v191, v127
    v_fma_f32 v188, v188, v108, -v172
    v_fma_f32 v189, v189, v109, -v173
    v_fma_f32 v190, v190, v110, -v174
    v_fma_f32 v191, v191, v111, -v175
    v_cvt_pk_bf16_f32 v140, v236, v188
    v_cvt_pk_bf16_f32 v141, v237, v189
    v_cvt_pk_bf16_f32 v142, v238, v190
    v_cvt_pk_bf16_f32 v143, v239, v191
    s_nop 1
    v_mfma_f32_32x32x16_bf16 v[204:219], v[44:47], v[140:143], 0
    v_mfma_f32_32x32x16_bf16 v[220:235], v[60:63], v[140:143], 0
    v_mul_f32 v236, v176, v112
    v_mul_f32 v237, v177, v113
    v_mul_f32 v238, v178, v114
    v_mul_f32 v239, v179, v115
    v_mul_f32 v176, v176, v128
    v_mul_f32 v177, v177, v129
    v_mul_f32 v178, v178, v130
    v_mul_f32 v179, v179, v131
    v_fmac_f32 v236, v192, v128
    v_fmac_f32 v237, v193, v129
    v_fmac_f32 v238, v194, v130
    v_fmac_f32 v239, v195, v131
    v_fma_f32 v192, v192, v112, -v176
    v_fma_f32 v193, v193, v113, -v177
    v_fma_f32 v194, v194, v114, -v178
    v_fma_f32 v195, v195, v115, -v179
    v_cvt_pk_bf16_f32 v144, v236, v192
    v_cvt_pk_bf16_f32 v145, v237, v193
    v_cvt_pk_bf16_f32 v146, v238, v194
    v_cvt_pk_bf16_f32 v147, v239, v195
    s_nop 1
    v_mfma_f32_32x32x16_bf16 v[204:219], v[48:51], v[144:147], v[204:219]
    v_mfma_f32_32x32x16_bf16 v[220:235], v[64:67], v[144:147], v[220:235]
    v_mul_f32 v236, v180, v116
    v_mul_f32 v237, v181, v117
    v_mul_f32 v238, v182, v118
    v_mul_f32 v239, v183, v119
    v_mul_f32 v180, v180, v132
    v_mul_f32 v181, v181, v133
    v_mul_f32 v182, v182, v134
    v_mul_f32 v183, v183, v135
    v_fmac_f32 v236, v196, v132
    v_fmac_f32 v237, v197, v133
    v_fmac_f32 v238, v198, v134
    v_fmac_f32 v239, v199, v135
    v_fma_f32 v196, v196, v116, -v180
    v_fma_f32 v197, v197, v117, -v181
    v_fma_f32 v198, v198, v118, -v182
    v_fma_f32 v199, v199, v119, -v183
    v_cvt_pk_bf16_f32 v148, v236, v196
    v_cvt_pk_bf16_f32 v149, v237, v197
    v_cvt_pk_bf16_f32 v150, v238, v198
    v_cvt_pk_bf16_f32 v151, v239, v199
    s_nop 1
    v_mfma_f32_32x32x16_bf16 v[204:219], v[52:55], v[148:151], v[204:219]
    v_mfma_f32_32x32x16_bf16 v[220:235], v[68:71], v[148:151], v[220:235]
    v_mul_f32 v236, v184, v120
    v_mul_f32 v237, v185, v121
    v_mul_f32 v238, v186, v122
    v_mul_f32 v239, v187, v123
    v_mul_f32 v184, v184, v136
    v_mul_f32 v185, v185, v137
    v_mul_f32 v186, v186, v138
    v_mul_f32 v187, v187, v139
    v_fmac_f32 v236, v200, v136
    v_fmac_f32 v237, v201, v137
    v_fmac_f32 v238, v202, v138
    v_fmac_f32 v239, v203, v139
    v_fma_f32 v200, v200, v120, -v184
    v_fma_f32 v201, v201, v121, -v185
    v_fma_f32 v202, v202, v122, -v186
    v_fma_f32 v203, v203, v123, -v187
    v_cvt_pk_bf16_f32 v152, v236, v200
    v_cvt_pk_bf16_f32 v153, v237, v201
    v_cvt_pk_bf16_f32 v154, v238, v202
    v_cvt_pk_bf16_f32 v155, v239, v203
    s_nop 1
    v_mfma_f32_32x32x16_bf16 v[204:219], v[56:59], v[152:155], v[204:219]
    v_mfma_f32_32x32x16_bf16 v[220:235], v[72:75], v[152:155], v[220:235]
    s_waitcnt vmcnt(0)
    s_barrier
    ds_read_b128 v[156:159], v10 offset:32768
    ds_read_b128 v[160:163], v10 offset:40960
    ds_read_b128 v[164:167], v10 offset:49152
    ds_read_b128 v[168:171], v10 offset:57344
    ds_read_b128 v[108:111], v244 offset:24576
    ds_read_b128 v[124:127], v244 offset:28672
    ds_read_b128 v[112:115], v244 offset:25600
    ds_read_b128 v[128:131], v244 offset:29696
    ds_read_b128 v[116:119], v244 offset:26624
    ds_read_b128 v[132:135], v244 offset:30720
    ds_read_b128 v[120:123], v244 offset:27648
    ds_read_b128 v[136:139], v244 offset:31744
    s_waitcnt lgkmcnt(8)
    v_lshlrev_b32 v240, 16, v156
    v_lshlrev_b32 v241, 16, v157
    v_lshlrev_b32 v242, 16, v158
    v_lshlrev_b32 v243, 16, v159
    v_and_b32 v156, s41, v156
    v_and_b32 v157, s41, v157
    v_and_b32 v158, s41, v158
    v_and_b32 v159, s41, v159
    v_mul_f32 v236, v220, v156
    v_mul_f32 v237, v221, v157
    v_mul_f32 v238, v222, v158
    v_mul_f32 v239, v223, v159
    v_mul_f32 v220, v220, v240
    v_mul_f32 v221, v221, v241
    v_mul_f32 v222, v222, v242
    v_mul_f32 v223, v223, v243
    v_fma_f32 v236, v204, v240, -v236
    v_fma_f32 v237, v205, v241, -v237
    v_fma_f32 v238, v206, v242, -v238
    v_fma_f32 v239, v207, v243, -v239
    v_fmac_f32 v220, v204, v156
    v_fmac_f32 v221, v205, v157
    v_fmac_f32 v222, v206, v158
    v_fmac_f32 v223, v207, v159
    v_cvt_pk_bf16_f32 v140, v236, -v220
    v_cvt_pk_bf16_f32 v141, v237, -v221
    v_cvt_pk_bf16_f32 v142, v238, -v222
    v_cvt_pk_bf16_f32 v143, v239, -v223
    s_nop 1
    v_mfma_f32_32x32x16_bf16 v[172:187], v[140:143], v[44:47], 0
    v_mfma_f32_32x32x16_bf16 v[188:203], v[140:143], v[60:63], 0
    v_lshlrev_b32 v240, 16, v160
    v_lshlrev_b32 v241, 16, v161
    v_lshlrev_b32 v242, 16, v162
    v_lshlrev_b32 v243, 16, v163
    v_and_b32 v160, s41, v160
    v_and_b32 v161, s41, v161
    v_and_b32 v162, s41, v162
    v_and_b32 v163, s41, v163
    v_mul_f32 v236, v224, v160
    v_mul_f32 v237, v225, v161
    v_mul_f32 v238, v226, v162
    v_mul_f32 v239, v227, v163
    v_mul_f32 v224, v224, v240
    v_mul_f32 v225, v225, v241
    v_mul_f32 v226, v226, v242
    v_mul_f32 v227, v227, v243
    v_fma_f32 v236, v208, v240, -v236
    v_fma_f32 v237, v209, v241, -v237
    v_fma_f32 v238, v210, v242, -v238
    v_fma_f32 v239, v211, v243, -v239
    v_fmac_f32 v224, v208, v160
    v_fmac_f32 v225, v209, v161
    v_fmac_f32 v226, v210, v162
    v_fmac_f32 v227, v211, v163
    v_cvt_pk_bf16_f32 v144, v236, -v224
    v_cvt_pk_bf16_f32 v145, v237, -v225
    v_cvt_pk_bf16_f32 v146, v238, -v226
    v_cvt_pk_bf16_f32 v147, v239, -v227
    s_nop 1
    v_mfma_f32_32x32x16_bf16 v[172:187], v[144:147], v[48:51], v[172:187]
    v_mfma_f32_32x32x16_bf16 v[188:203], v[144:147], v[64:67], v[188:203]
    v_lshlrev_b32 v240, 16, v164
    v_lshlrev_b32 v241, 16, v165
    v_lshlrev_b32 v242, 16, v166
    v_lshlrev_b32 v243, 16, v167
    v_and_b32 v164, s41, v164
    v_and_b32 v165, s41, v165
    v_and_b32 v166, s41, v166
    v_and_b32 v167, s41, v167
    v_mul_f32 v236, v228, v164
    v_mul_f32 v237, v229, v165
    v_mul_f32 v238, v230, v166
    v_mul_f32 v239, v231, v167
    v_mul_f32 v228, v228, v240
    v_mul_f32 v229, v229, v241
    v_mul_f32 v230, v230, v242
    v_mul_f32 v231, v231, v243
    v_fma_f32 v236, v212, v240, -v236
    v_fma_f32 v237, v213, v241, -v237
    v_fma_f32 v238, v214, v242, -v238
    v_fma_f32 v239, v215, v243, -v239
    v_fmac_f32 v228, v212, v164
    v_fmac_f32 v229, v213, v165
    v_fmac_f32 v230, v214, v166
    v_fmac_f32 v231, v215, v167
    v_cvt_pk_bf16_f32 v148, v236, -v228
    v_cvt_pk_bf16_f32 v149, v237, -v229
    v_cvt_pk_bf16_f32 v150, v238, -v230
    v_cvt_pk_bf16_f32 v151, v239, -v231
    s_nop 1
    v_mfma_f32_32x32x16_bf16 v[172:187], v[148:151], v[52:55], v[172:187]
    v_mfma_f32_32x32x16_bf16 v[188:203], v[148:151], v[68:71], v[188:203]
    v_lshlrev_b32 v240, 16, v168
    v_lshlrev_b32 v241, 16, v169
    v_lshlrev_b32 v242, 16, v170
    v_lshlrev_b32 v243, 16, v171
    v_and_b32 v168, s41, v168
    v_and_b32 v169, s41, v169
    v_and_b32 v170, s41, v170
    v_and_b32 v171, s41, v171
    v_mul_f32 v236, v232, v168
    v_mul_f32 v237, v233, v169
    v_mul_f32 v238, v234, v170
    v_mul_f32 v239, v235, v171
    v_mul_f32 v232, v232, v240
    v_mul_f32 v233, v233, v241
    v_mul_f32 v234, v234, v242
    v_mul_f32 v235, v235, v243
    v_fma_f32 v236, v216, v240, -v236
    v_fma_f32 v237, v217, v241, -v237
    v_fma_f32 v238, v218, v242, -v238
    v_fma_f32 v239, v219, v243, -v239
    v_fmac_f32 v232, v216, v168
    v_fmac_f32 v233, v217, v169
    v_fmac_f32 v234, v218, v170
    v_fmac_f32 v235, v219, v171
    v_cvt_pk_bf16_f32 v152, v236, -v232
    v_cvt_pk_bf16_f32 v153, v237, -v233
    v_cvt_pk_bf16_f32 v154, v238, -v234
    v_cvt_pk_bf16_f32 v155, v239, -v235
    s_nop 1
    v_mfma_f32_32x32x16_bf16 v[172:187], v[152:155], v[56:59], v[172:187]
    v_mfma_f32_32x32x16_bf16 v[188:203], v[152:155], v[72:75], v[188:203]
    s_waitcnt lgkmcnt(0)
    s_nop 9
    v_mul_f32 v236, v172, v108
    v_mul_f32 v237, v173, v109
    v_mul_f32 v238, v174, v110
    v_mul_f32 v239, v175, v111
    v_mul_f32 v172, v172, v124
    v_mul_f32 v173, v173, v125
    v_mul_f32 v174, v174, v126
    v_mul_f32 v175, v175, v127
    v_fmac_f32 v236, v188, v124
    v_fmac_f32 v237, v189, v125
    v_fmac_f32 v238, v190, v126
    v_fmac_f32 v239, v191, v127
    v_fma_f32 v188, v188, v108, -v172
    v_fma_f32 v189, v189, v109, -v173
    v_fma_f32 v190, v190, v110, -v174
    v_fma_f32 v191, v191, v111, -v175
    v_cvt_pk_bf16_f32 v140, v236, v188
    v_cvt_pk_bf16_f32 v141, v237, v189
    v_cvt_pk_bf16_f32 v142, v238, v190
    v_cvt_pk_bf16_f32 v143, v239, v191
    s_nop 1
    v_mfma_f32_32x32x16_bf16 v[204:219], v[140:143], v[76:79], 0
    v_mfma_f32_32x32x16_bf16 v[220:235], v[140:143], v[92:95], 0
    v_mul_f32 v236, v176, v112
    v_mul_f32 v237, v177, v113
    v_mul_f32 v238, v178, v114
    v_mul_f32 v239, v179, v115
    v_mul_f32 v176, v176, v128
    v_mul_f32 v177, v177, v129
    v_mul_f32 v178, v178, v130
    v_mul_f32 v179, v179, v131
    v_fmac_f32 v236, v192, v128
    v_fmac_f32 v237, v193, v129
    v_fmac_f32 v238, v194, v130
    v_fmac_f32 v239, v195, v131
    v_fma_f32 v192, v192, v112, -v176
    v_fma_f32 v193, v193, v113, -v177
    v_fma_f32 v194, v194, v114, -v178
    v_fma_f32 v195, v195, v115, -v179
    v_cvt_pk_bf16_f32 v144, v236, v192
    v_cvt_pk_bf16_f32 v145, v237, v193
    v_cvt_pk_bf16_f32 v146, v238, v194
    v_cvt_pk_bf16_f32 v147, v239, v195
    s_nop 1
    v_mfma_f32_32x32x16_bf16 v[204:219], v[144:147], v[80:83], v[204:219]
    v_mfma_f32_32x32x16_bf16 v[220:235], v[144:147], v[96:99], v[220:235]
    v_mul_f32 v236, v180, v116
    v_mul_f32 v237, v181, v117
    v_mul_f32 v238, v182, v118
    v_mul_f32 v239, v183, v119
    v_mul_f32 v180, v180, v132
    v_mul_f32 v181, v181, v133
    v_mul_f32 v182, v182, v134
    v_mul_f32 v183, v183, v135
    v_fmac_f32 v236, v196, v132
    v_fmac_f32 v237, v197, v133
    v_fmac_f32 v238, v198, v134
    v_fmac_f32 v239, v199, v135
    v_fma_f32 v196, v196, v116, -v180
    v_fma_f32 v197, v197, v117, -v181
    v_fma_f32 v198, v198, v118, -v182
    v_fma_f32 v199, v199, v119, -v183
    v_cvt_pk_bf16_f32 v148, v236, v196
    v_cvt_pk_bf16_f32 v149, v237, v197
    v_cvt_pk_bf16_f32 v150, v238, v198
    v_cvt_pk_bf16_f32 v151, v239, v199
    s_nop 1
    v_mfma_f32_32x32x16_bf16 v[204:219], v[148:151], v[84:87], v[204:219]
    v_mfma_f32_32x32x16_bf16 v[220:235], v[148:151], v[100:103], v[220:235]
    v_mul_f32 v236, v184, v120
    v_mul_f32 v237, v185, v121
    v_mul_f32 v238, v186, v122
    v_mul_f32 v239, v187, v123
    v_mul_f32 v184, v184, v136
    v_mul_f32 v185, v185, v137
    v_mul_f32 v186, v186, v138
    v_mul_f32 v187, v187, v139
    v_fmac_f32 v236, v200, v136
    v_fmac_f32 v237, v201, v137
    v_fmac_f32 v238, v202, v138
    v_fmac_f32 v239, v203, v139
    v_fma_f32 v200, v200, v120, -v184
    v_fma_f32 v201, v201, v121, -v185
    v_fma_f32 v202, v202, v122, -v186
    v_fma_f32 v203, v203, v123, -v187
    v_cvt_pk_bf16_f32 v152, v236, v200
    v_cvt_pk_bf16_f32 v153, v237, v201
    v_cvt_pk_bf16_f32 v154, v238, v202
    v_cvt_pk_bf16_f32 v155, v239, v203
    s_nop 1
    v_mfma_f32_32x32x16_bf16 v[204:219], v[152:155], v[88:91], v[204:219]
    v_mfma_f32_32x32x16_bf16 v[220:235], v[152:155], v[104:107], v[220:235]
    v_xor_b32 v237, 16, v11
    v_xor_b32 v238, 32, v11
    v_xor_b32 v239, 48, v11
    s_nop 8
    v_cvt_pk_bf16_f32 v156, v204, -v220
    v_cvt_pk_bf16_f32 v157, v205, -v221
    v_cvt_pk_bf16_f32 v158, v206, -v222
    v_cvt_pk_bf16_f32 v159, v207, -v223
    ds_write_b128 v11, v[156:159] offset:0
    v_cvt_pk_bf16_f32 v160, v208, -v224
    v_cvt_pk_bf16_f32 v161, v209, -v225
    v_cvt_pk_bf16_f32 v162, v210, -v226
    v_cvt_pk_bf16_f32 v163, v211, -v227
    ds_write_b128 v237, v[160:163] offset:256
    v_cvt_pk_bf16_f32 v164, v212, -v228
    v_cvt_pk_bf16_f32 v165, v213, -v229
    v_cvt_pk_bf16_f32 v166, v214, -v230
    v_cvt_pk_bf16_f32 v167, v215, -v231
    ds_write_b128 v238, v[164:167] offset:512
    v_cvt_pk_bf16_f32 v168, v216, -v232
    v_cvt_pk_bf16_f32 v169, v217, -v233
    v_cvt_pk_bf16_f32 v170, v218, -v234
    v_cvt_pk_bf16_f32 v171, v219, -v235
    ds_write_b128 v239, v[168:171] offset:768
    v_subrev_u32 v4, 65536, v4
    s_waitcnt lgkmcnt(0)
    s_barrier
    ds_read_b128 v[172:175], v4 offset:0
    ds_read_b128 v[176:179], v4 offset:8192
    ds_read_b128 v[180:183], v4 offset:16384
    ds_read_b128 v[184:187], v4 offset:24576
    s_waitcnt lgkmcnt(3)
    buffer_store_dwordx4 v[172:175], v7, s[20:23], s42 offen sc1
    s_add_u32 s42, s42, 8192
    s_waitcnt lgkmcnt(2)
    buffer_store_dwordx4 v[176:179], v7, s[20:23], s42 offen sc1
    s_add_u32 s42, s42, 8192
    s_waitcnt lgkmcnt(1)
    buffer_store_dwordx4 v[180:183], v7, s[20:23], s42 offen sc1
    s_add_u32 s42, s42, 8192
    s_waitcnt lgkmcnt(0)
    buffer_store_dwordx4 v[184:187], v7, s[20:23], s42 offen sc1
    s_lshl_b32 s58, s2, 6
    s_add_u32 s58, s58, 17408
    s_waitcnt vmcnt(0)
    s_barrier
    s_cmp_lg_u32 s3, 0
    s_cbranch_scc1 nofl7
    s_mov_b32 s60, s6
    s_mov_b32 s61, s7
    s_mov_b32 s62, 524288
    s_mov_b32 s63, 0x00020000
    v_mov_b32 v246, s92
    v_mov_b32 v247, s93
    v_and_b32 v248, 63, v0
    v_lshlrev_b32 v248, 3, v248
    s_mov_b64 exec, 0xff
    buffer_store_dwordx2 v[246:247], v248, s[60:63], s58 offen sc1
    s_mov_b64 exec, -1
nofl7:
    s_branch k3_start
k2_loader:
    s_lshr_b32 s10, s2, 5
    s_sub_u32 s10, s10, 3
    s_and_b32 s24, s2, 7
    s_lshl_b32 s24, s24, 2
    s_bfe_u32 s11, s2, 0x20003
    s_add_u32 s24, s24, s11
    s_lshr_b32 s25, s24, 4
    s_and_b32 s26, s24, 15
    v_and_b32 v1, 63, v0
    v_lshrrev_b32 v3, 4, v1
    v_lshlrev_b32 v2, 2, v3
    v_and_b32 v4, 15, v0
    v_xor_b32 v4, v4, v2
    v_mul_u32_u24 v5, 1280, v3
    v_lshl_add_u32 v5, v4, 4, v5
    s_sub_u32 s27, s3, 4
    s_mul_i32 s28, s25, 216
    s_add_u32 s28, s28, s27
    s_mul_i32 s28, s28, 5120
    s_lshl_b32 s29, s10, 8
    s_add_u32 s28, s28, s29
    s_lshl_b32 s29, s27, 10
    s_mov_b32 s12, s80
    s_mov_b32 s13, s81
    s_mov_b32 s14, 2211840
    s_mov_b32 s15, 0x00020000
k2_lmain:
    s_add_u32 m0, s29, 0
    s_add_u32 s27, s28, 0
    buffer_load_dwordx4 v5, s[12:15], s27 offen lds
    s_add_u32 m0, s29, 4096
    s_add_u32 s27, s28, 20480
    buffer_load_dwordx4 v5, s[12:15], s27 offen lds
    s_add_u32 m0, s29, 8192
    s_add_u32 s27, s28, 40960
    buffer_load_dwordx4 v5, s[12:15], s27 offen lds
    s_add_u32 m0, s29, 12288
    s_add_u32 s27, s28, 61440
    buffer_load_dwordx4 v5, s[12:15], s27 offen lds
    s_add_u32 m0, s29, 16384
    s_add_u32 s27, s28, 81920
    buffer_load_dwordx4 v5, s[12:15], s27 offen lds
    s_add_u32 m0, s29, 20480
    s_add_u32 s27, s28, 102400
    buffer_load_dwordx4 v5, s[12:15], s27 offen lds
    s_add_u32 m0, s29, 24576
    s_add_u32 s27, s28, 122880
    buffer_load_dwordx4 v5, s[12:15], s27 offen lds
    s_add_u32 m0, s29, 28672
    s_add_u32 s27, s28, 143360
    buffer_load_dwordx4 v5, s[12:15], s27 offen lds
    s_add_u32 m0, s29, 32768
    s_add_u32 s27, s28, 163840
    buffer_load_dwordx4 v5, s[12:15], s27 offen lds
    s_add_u32 m0, s29, 36864
    s_add_u32 s27, s28, 184320
    buffer_load_dwordx4 v5, s[12:15], s27 offen lds
    s_add_u32 m0, s29, 40960
    s_add_u32 s27, s28, 204800
    buffer_load_dwordx4 v5, s[12:15], s27 offen lds
    s_add_u32 m0, s29, 45056
    s_add_u32 s27, s28, 225280
    buffer_load_dwordx4 v5, s[12:15], s27 offen lds
    s_add_u32 m0, s29, 49152
    s_add_u32 s27, s28, 245760
    buffer_load_dwordx4 v5, s[12:15], s27 offen lds
    s_add_u32 m0, s29, 53248
    s_add_u32 s27, s28, 266240
    buffer_load_dwordx4 v5, s[12:15], s27 offen lds
    s_add_u32 m0, s29, 57344
    s_add_u32 s27, s28, 286720
    buffer_load_dwordx4 v5, s[12:15], s27 offen lds
    s_add_u32 m0, s29, 61440
    s_add_u32 s27, s28, 307200
    buffer_load_dwordx4 v5, s[12:15], s27 offen lds
    s_add_u32 m0, s29, 65536
    s_add_u32 s27, s28, 327680
    buffer_load_dwordx4 v5, s[12:15], s27 offen lds
    s_add_u32 m0, s29, 69632
    s_add_u32 s27, s28, 348160
    buffer_load_dwordx4 v5, s[12:15], s27 offen lds
    s_add_u32 m0, s29, 73728
    s_add_u32 s27, s28, 368640
    buffer_load_dwordx4 v5, s[12:15], s27 offen lds
    s_add_u32 m0, s29, 77824
    s_add_u32 s27, s28, 389120
    buffer_load_dwordx4 v5, s[12:15], s27 offen lds
    s_add_u32 m0, s29, 81920
    s_add_u32 s27, s28, 409600
    buffer_load_dwordx4 v5, s[12:15], s27 offen lds
    s_add_u32 m0, s29, 86016
    s_add_u32 s27, s28, 430080
    buffer_load_dwordx4 v5, s[12:15], s27 offen lds
    s_add_u32 m0, s29, 90112
    s_add_u32 s27, s28, 450560
    buffer_load_dwordx4 v5, s[12:15], s27 offen lds
    s_add_u32 m0, s29, 94208
    s_add_u32 s27, s28, 471040
    buffer_load_dwordx4 v5, s[12:15], s27 offen lds
    s_cmp_lg_u32 s3, 4
    s_cbranch_scc1 k2_nph
    s_movk_i32 s34, 0x3fff
    s_mul_i32 s35, s25, 13
    s_lshl_b32 s34, s34, s35
    s_mov_b32 s35, s34
    s_lshl_b32 s33, s26, 12
    s_add_u32 s33, s33, 131072
    s_mov_b32 s60, s6
    s_mov_b32 s61, s7
    s_mov_b32 s62, 524288
    s_mov_b32 s63, 0x00020000
    v_and_b32 v10, 63, v0
    v_lshlrev_b32 v10, 6, v10
    s_mov_b32 s59, 0
    s_mov_b64 s[56:57], s[34:35]
    s_ff1_i32_b64 s95, s[56:57]
    s_lshl_b64 exec, 1, s95
poll8a:
    buffer_load_dwordx2 v[8:9], v10, s[60:63], s33 offen sc1
    s_waitcnt vmcnt(0)
    v_cmp_ne_u64 vcc, s[92:93], v[8:9]
    s_nop 4
    s_cbranch_vccz poll8
    s_add_u32 s59, s59, 1
    s_cmp_ge_u32 s59, 0x8000
    s_cbranch_scc1 poll8d
    s_sleep 8
    s_branch poll8a
poll8:
    s_mov_b64 exec, s[56:57]
    buffer_load_dwordx2 v[8:9], v10, s[60:63], s33 offen sc1
    s_waitcnt vmcnt(0)
    v_cmp_ne_u64 s[56:57], s[92:93], v[8:9]
    s_nop 1
    s_mov_b64 vcc, s[56:57]
    s_cbranch_vccz poll8d
    s_add_u32 s59, s59, 1
    s_cmp_ge_u32 s59, 0x8000
    s_cbranch_scc1 poll8d
    s_sleep 2
    s_branch poll8
poll8d:
    s_mov_b64 exec, -1
k2_nph:
    s_barrier
    s_add_u32 m0, s29, 98304
    s_add_u32 s27, s28, 491520
    buffer_load_dwordx4 v5, s[12:15], s27 offen lds
    s_add_u32 m0, s29, 102400
    s_add_u32 s27, s28, 512000
    buffer_load_dwordx4 v5, s[12:15], s27 offen lds
    s_add_u32 m0, s29, 106496
    s_add_u32 s27, s28, 532480
    buffer_load_dwordx4 v5, s[12:15], s27 offen lds
    s_add_u32 m0, s29, 110592
    s_add_u32 s27, s28, 552960
    buffer_load_dwordx4 v5, s[12:15], s27 offen lds
    s_add_u32 m0, s29, 114688
    s_add_u32 s27, s28, 573440
    buffer_load_dwordx4 v5, s[12:15], s27 offen lds
    s_add_u32 m0, s29, 118784
    s_add_u32 s27, s28, 593920
    buffer_load_dwordx4 v5, s[12:15], s27 offen lds
    s_waitcnt vmcnt(24)
    s_barrier
    s_waitcnt vmcnt(18)
    s_barrier
    s_add_u32 m0, s29, 122880
    s_add_u32 s27, s28, 614400
    buffer_load_dwordx4 v5, s[12:15], s27 offen lds
    s_add_u32 m0, s29, 126976
    s_add_u32 s27, s28, 634880
    buffer_load_dwordx4 v5, s[12:15], s27 offen lds
    s_add_u32 m0, s29, 131072
    s_add_u32 s27, s28, 655360
    buffer_load_dwordx4 v5, s[12:15], s27 offen lds
    s_add_u32 m0, s29, 135168
    s_add_u32 s27, s28, 675840
    buffer_load_dwordx4 v5, s[12:15], s27 offen lds
    s_add_u32 m0, s29, 139264
    s_add_u32 s27, s28, 696320
    buffer_load_dwordx4 v5, s[12:15], s27 offen lds
    s_add_u32 m0, s29, 143360
    s_add_u32 s27, s28, 716800
    buffer_load_dwordx4 v5, s[12:15], s27 offen lds
    s_waitcnt vmcnt(18)
    s_barrier
    s_add_u32 m0, s29, 0
    s_add_u32 s27, s28, 737280
    buffer_load_dwordx4 v5, s[12:15], s27 offen lds
    s_add_u32 m0, s29, 4096
    s_add_u32 s27, s28, 757760
    buffer_load_dwordx4 v5, s[12:15], s27 offen lds
    s_add_u32 m0, s29, 8192
    s_add_u32 s27, s28, 778240
    buffer_load_dwordx4 v5, s[12:15], s27 offen lds
    s_add_u32 m0, s29, 12288
    s_add_u32 s27, s28, 798720
    buffer_load_dwordx4 v5, s[12:15], s27 offen lds
    s_add_u32 m0, s29, 16384
    s_add_u32 s27, s28, 819200
    buffer_load_dwordx4 v5, s[12:15], s27 offen lds
    s_add_u32 m0, s29, 20480
    s_add_u32 s27, s28, 839680
    buffer_load_dwordx4 v5, s[12:15], s27 offen lds
    s_waitcnt vmcnt(18)
    s_barrier
    s_add_u32 m0, s29, 24576
    s_add_u32 s27, s28, 860160
    buffer_load_dwordx4 v5, s[12:15], s27 offen lds
    s_add_u32 m0, s29, 28672
    s_add_u32 s27, s28, 880640
    buffer_load_dwordx4 v5, s[12:15], s27 offen lds
    s_add_u32 m0, s29, 32768
    s_add_u32 s27, s28, 901120
    buffer_load_dwordx4 v5, s[12:15], s27 offen lds
    s_add_u32 m0, s29, 36864
    s_add_u32 s27, s28, 921600
    buffer_load_dwordx4 v5, s[12:15], s27 offen lds
    s_add_u32 m0, s29, 40960
    s_add_u32 s27, s28, 942080
    buffer_load_dwordx4 v5, s[12:15], s27 offen lds
    s_add_u32 m0, s29, 45056
    s_add_u32 s27, s28, 962560
    buffer_load_dwordx4 v5, s[12:15], s27 offen lds
    s_waitcnt vmcnt(18)
    s_barrier
    s_add_u32 m0, s29, 49152
    s_add_u32 s27, s28, 983040
    buffer_load_dwordx4 v5, s[12:15], s27 offen lds
    s_add_u32 m0, s29, 53248
    s_add_u32 s27, s28, 1003520
    buffer_load_dwordx4 v5, s[12:15], s27 offen lds
    s_add_u32 m0, s29, 57344
    s_add_u32 s27, s28, 1024000
    buffer_load_dwordx4 v5, s[12:15], s27 offen lds
    s_add_u32 m0, s29, 61440
    s_add_u32 s27, s28, 1044480
    buffer_load_dwordx4 v5, s[12:15], s27 offen lds
    s_add_u32 m0, s29, 65536
    s_add_u32 s27, s28, 1064960
    buffer_load_dwordx4 v5, s[12:15], s27 offen lds
    s_add_u32 m0, s29, 69632
    s_add_u32 s27, s28, 1085440
    buffer_load_dwordx4 v5, s[12:15], s27 offen lds
    s_waitcnt vmcnt(18)
    s_barrier
    s_waitcnt vmcnt(12)
    s_barrier
    s_waitcnt vmcnt(6)
    s_barrier
    s_waitcnt vmcnt(0)
    s_barrier
    s_getpc_b64 s[96:97]
k2_cpf:
    s_add_u32 s96, s96, k3_start-k2_cpf
    s_addc_u32 s97, s97, 0
    v_and_b32 v250, 255, v0
    v_lshlrev_b32 v250, 5, v250
    v_min_u32 v250, text_end-k3_start-16, v250
    v_mov_b32 v251, s97
    v_add_co_u32 v250, vcc, s96, v250
    s_nop 1
    v_addc_co_u32 v251, vcc, 0, v251, vcc
    global_load_dword v252, v[250:251], off
    s_branch k3_start
k2_comp:
    s_lshr_b32 s10, s2, 5
    s_sub_u32 s10, s10, 3
    s_and_b32 s24, s2, 7
    s_lshl_b32 s24, s24, 2
    s_bfe_u32 s11, s2, 0x20003
    s_add_u32 s24, s24, s11
    s_lshr_b32 s25, s24, 4
    s_and_b32 s26, s24, 15
    v_and_b32 v1, 63, v0
    v_lshlrev_b32 v5, 4, v1
    s_lshl_b32 s27, s26, 2
    s_add_u32 s27, s27, s3
    s_mul_i32 s28, s27, 108
    s_mul_i32 s29, s25, 54
    s_add_u32 s28, s28, s29
    s_lshl_b32 s28, s28, 10
    s_add_u32 s12, s6, 524288
    s_addc_u32 s13, s7, 0
    s_mov_b32 s14, 7077888
    s_mov_b32 s15, 0x00020000
    s_add_u32 s16, s6, 20971520
    s_addc_u32 s17, s7, 0
    s_mov_b32 s18, 5242880
    s_mov_b32 s19, 0x00020000
    v_bfe_u32 v2, v0, 2, 2
    v_bfe_u32 v3, v0, 5, 1
    v_lshl_add_u32 v4, v3, 2, v2
    v_lshlrev_b32 v4, 8, v4
    v_lshl_add_u32 v4, v2, 6, v4
    v_bfe_u32 v2, v0, 4, 1
    v_lshl_add_u32 v4, v2, 5, v4
    v_and_b32 v2, 1, v0
    v_lshl_add_u32 v4, v2, 4, v4
    v_bfe_u32 v2, v0, 1, 1
    v_lshl_add_u32 v176, v2, 3, v4
    v_xor_b32 v177, 64, v176
    v_xor_b32 v178, 128, v176
    v_xor_b32 v179, 192, v176
    v_add_u32 v180, 49152, v176
    v_add_u32 v181, 49152, v177
    v_add_u32 v182, 49152, v178
    v_add_u32 v183, 49152, v179
    v_add_u32 v184, 98304, v176
    v_add_u32 v185, 98304, v177
    v_add_u32 v186, 98304, v178
    v_add_u32 v187, 98304, v179
    s_mul_i32 s30, s25, 2621440
    s_mul_i32 s31, s27, 40960
    s_add_u32 s30, s30, s31
    s_lshl_b32 s31, s10, 13
    s_add_u32 s30, s30, s31
    s_add_u32 s31, s30, 4096
    s_lshl_b32 s32, s27, 10
    s_barrier
    s_add_u32 s29, s28, 0
    buffer_load_dwordx4 v[8:11], v5, s[12:15], s29 offen offset:0 sc1
    buffer_load_dwordx4 v[12:15], v5, s[12:15], s29 offen offset:1024 sc1
    buffer_load_dwordx4 v[16:19], v5, s[12:15], s29 offen offset:2048 sc1
    buffer_load_dwordx4 v[20:23], v5, s[12:15], s29 offen offset:3072 sc1
    s_add_u32 s29, s28, 4096
    buffer_load_dwordx4 v[24:27], v5, s[12:15], s29 offen offset:0 sc1
    buffer_load_dwordx4 v[28:31], v5, s[12:15], s29 offen offset:1024 sc1
    buffer_load_dwordx4 v[32:35], v5, s[12:15], s29 offen offset:2048 sc1
    buffer_load_dwordx4 v[36:39], v5, s[12:15], s29 offen offset:3072 sc1
    s_add_u32 s29, s28, 8192
    buffer_load_dwordx4 v[40:43], v5, s[12:15], s29 offen offset:0 sc1
    buffer_load_dwordx4 v[44:47], v5, s[12:15], s29 offen offset:1024 sc1
    buffer_load_dwordx4 v[48:51], v5, s[12:15], s29 offen offset:2048 sc1
    buffer_load_dwordx4 v[52:55], v5, s[12:15], s29 offen offset:3072 sc1
    s_add_u32 s29, s28, 12288
    buffer_load_dwordx4 v[56:59], v5, s[12:15], s29 offen offset:0 sc1
    buffer_load_dwordx4 v[60:63], v5, s[12:15], s29 offen offset:1024 sc1
    s_barrier
    ds_read_b64_tr_b16 v[128:129], v176 offset:0
    ds_read_b64_tr_b16 v[130:131], v176 offset:2048
    ds_read_b64_tr_b16 v[132:133], v177 offset:0
    ds_read_b64_tr_b16 v[134:135], v177 offset:2048
    ds_read_b64_tr_b16 v[136:137], v178 offset:0
    ds_read_b64_tr_b16 v[138:139], v178 offset:2048
    ds_read_b64_tr_b16 v[140:141], v179 offset:0
    ds_read_b64_tr_b16 v[142:143], v179 offset:2048
    ds_read_b64_tr_b16 v[144:145], v176 offset:4096
    ds_read_b64_tr_b16 v[146:147], v176 offset:6144
    ds_read_b64_tr_b16 v[148:149], v177 offset:4096
    ds_read_b64_tr_b16 v[150:151], v177 offset:6144
    ds_read_b64_tr_b16 v[152:153], v178 offset:4096
    ds_read_b64_tr_b16 v[154:155], v178 offset:6144
    ds_read_b64_tr_b16 v[156:157], v179 offset:4096
    ds_read_b64_tr_b16 v[158:159], v179 offset:6144
    s_waitcnt vmcnt(13)
    s_waitcnt lgkmcnt(12)
    v_mfma_f32_32x32x16_bf16 v[64:79], v[128:131], v[8:11], 0
    ds_read_b64_tr_b16 v[160:161], v176 offset:8192
    ds_read_b64_tr_b16 v[162:163], v176 offset:10240
    v_mfma_f32_32x32x16_bf16 v[80:95], v[132:135], v[8:11], 0
    ds_read_b64_tr_b16 v[164:165], v177 offset:8192
    ds_read_b64_tr_b16 v[166:167], v177 offset:10240
    s_waitcnt lgkmcnt(12)
    v_mfma_f32_32x32x16_bf16 v[96:111], v[136:139], v[8:11], 0
    ds_read_b64_tr_b16 v[168:169], v178 offset:8192
    ds_read_b64_tr_b16 v[170:171], v178 offset:10240
    v_mfma_f32_32x32x16_bf16 v[112:127], v[140:143], v[8:11], 0
    ds_read_b64_tr_b16 v[172:173], v179 offset:8192
    ds_read_b64_tr_b16 v[174:175], v179 offset:10240
    buffer_load_dwordx4 v[8:11], v5, s[12:15], s29 offen offset:2048 sc1
    s_waitcnt vmcnt(13)
    s_waitcnt lgkmcnt(12)
    v_mfma_f32_32x32x16_bf16 v[64:79], v[144:147], v[12:15], v[64:79]
    ds_read_b64_tr_b16 v[128:129], v176 offset:12288
    ds_read_b64_tr_b16 v[130:131], v176 offset:14336
    v_mfma_f32_32x32x16_bf16 v[80:95], v[148:151], v[12:15], v[80:95]
    ds_read_b64_tr_b16 v[132:133], v177 offset:12288
    ds_read_b64_tr_b16 v[134:135], v177 offset:14336
    s_waitcnt lgkmcnt(12)
    v_mfma_f32_32x32x16_bf16 v[96:111], v[152:155], v[12:15], v[96:111]
    ds_read_b64_tr_b16 v[136:137], v178 offset:12288
    ds_read_b64_tr_b16 v[138:139], v178 offset:14336
    v_mfma_f32_32x32x16_bf16 v[112:127], v[156:159], v[12:15], v[112:127]
    ds_read_b64_tr_b16 v[140:141], v179 offset:12288
    ds_read_b64_tr_b16 v[142:143], v179 offset:14336
    buffer_load_dwordx4 v[12:15], v5, s[12:15], s29 offen offset:3072 sc1
    s_waitcnt vmcnt(13)
    s_waitcnt lgkmcnt(12)
    v_mfma_f32_32x32x16_bf16 v[64:79], v[160:163], v[16:19], v[64:79]
    ds_read_b64_tr_b16 v[144:145], v176 offset:16384
    ds_read_b64_tr_b16 v[146:147], v176 offset:18432
    v_mfma_f32_32x32x16_bf16 v[80:95], v[164:167], v[16:19], v[80:95]
    ds_read_b64_tr_b16 v[148:149], v177 offset:16384
    ds_read_b64_tr_b16 v[150:151], v177 offset:18432
    s_waitcnt lgkmcnt(12)
    v_mfma_f32_32x32x16_bf16 v[96:111], v[168:171], v[16:19], v[96:111]
    ds_read_b64_tr_b16 v[152:153], v178 offset:16384
    ds_read_b64_tr_b16 v[154:155], v178 offset:18432
    v_mfma_f32_32x32x16_bf16 v[112:127], v[172:175], v[16:19], v[112:127]
    ds_read_b64_tr_b16 v[156:157], v179 offset:16384
    ds_read_b64_tr_b16 v[158:159], v179 offset:18432
    s_add_u32 s29, s28, 16384
    buffer_load_dwordx4 v[16:19], v5, s[12:15], s29 offen offset:0 sc1
    s_waitcnt vmcnt(13)
    s_waitcnt lgkmcnt(12)
    v_mfma_f32_32x32x16_bf16 v[64:79], v[128:131], v[20:23], v[64:79]
    ds_read_b64_tr_b16 v[160:161], v176 offset:20480
    ds_read_b64_tr_b16 v[162:163], v176 offset:22528
    v_mfma_f32_32x32x16_bf16 v[80:95], v[132:135], v[20:23], v[80:95]
    ds_read_b64_tr_b16 v[164:165], v177 offset:20480
    ds_read_b64_tr_b16 v[166:167], v177 offset:22528
    s_waitcnt lgkmcnt(12)
    v_mfma_f32_32x32x16_bf16 v[96:111], v[136:139], v[20:23], v[96:111]
    ds_read_b64_tr_b16 v[168:169], v178 offset:20480
    ds_read_b64_tr_b16 v[170:171], v178 offset:22528
    v_mfma_f32_32x32x16_bf16 v[112:127], v[140:143], v[20:23], v[112:127]
    ds_read_b64_tr_b16 v[172:173], v179 offset:20480
    ds_read_b64_tr_b16 v[174:175], v179 offset:22528
    buffer_load_dwordx4 v[20:23], v5, s[12:15], s29 offen offset:1024 sc1
    s_barrier
    s_waitcnt vmcnt(13)
    s_waitcnt lgkmcnt(12)
    v_mfma_f32_32x32x16_bf16 v[64:79], v[144:147], v[24:27], v[64:79]
    ds_read_b64_tr_b16 v[128:129], v176 offset:24576
    ds_read_b64_tr_b16 v[130:131], v176 offset:26624
    v_mfma_f32_32x32x16_bf16 v[80:95], v[148:151], v[24:27], v[80:95]
    ds_read_b64_tr_b16 v[132:133], v177 offset:24576
    ds_read_b64_tr_b16 v[134:135], v177 offset:26624
    s_waitcnt lgkmcnt(12)
    v_mfma_f32_32x32x16_bf16 v[96:111], v[152:155], v[24:27], v[96:111]
    ds_read_b64_tr_b16 v[136:137], v178 offset:24576
    ds_read_b64_tr_b16 v[138:139], v178 offset:26624
    v_mfma_f32_32x32x16_bf16 v[112:127], v[156:159], v[24:27], v[112:127]
    ds_read_b64_tr_b16 v[140:141], v179 offset:24576
    ds_read_b64_tr_b16 v[142:143], v179 offset:26624
    buffer_load_dwordx4 v[24:27], v5, s[12:15], s29 offen offset:2048 sc1
    s_waitcnt vmcnt(13)
    s_waitcnt lgkmcnt(12)
    v_mfma_f32_32x32x16_bf16 v[64:79], v[160:163], v[28:31], v[64:79]
    ds_read_b64_tr_b16 v[144:145], v176 offset:28672
    ds_read_b64_tr_b16 v[146:147], v176 offset:30720
    v_mfma_f32_32x32x16_bf16 v[80:95], v[164:167], v[28:31], v[80:95]
    ds_read_b64_tr_b16 v[148:149], v177 offset:28672
    ds_read_b64_tr_b16 v[150:151], v177 offset:30720
    s_waitcnt lgkmcnt(12)
    v_mfma_f32_32x32x16_bf16 v[96:111], v[168:171], v[28:31], v[96:111]
    ds_read_b64_tr_b16 v[152:153], v178 offset:28672
    ds_read_b64_tr_b16 v[154:155], v178 offset:30720
    v_mfma_f32_32x32x16_bf16 v[112:127], v[172:175], v[28:31], v[112:127]
    ds_read_b64_tr_b16 v[156:157], v179 offset:28672
    ds_read_b64_tr_b16 v[158:159], v179 offset:30720
    buffer_load_dwordx4 v[28:31], v5, s[12:15], s29 offen offset:3072 sc1
    s_waitcnt vmcnt(13)
    s_waitcnt lgkmcnt(12)
    v_mfma_f32_32x32x16_bf16 v[64:79], v[128:131], v[32:35], v[64:79]
    ds_read_b64_tr_b16 v[160:161], v176 offset:32768
    ds_read_b64_tr_b16 v[162:163], v176 offset:34816
    v_mfma_f32_32x32x16_bf16 v[80:95], v[132:135], v[32:35], v[80:95]
    ds_read_b64_tr_b16 v[164:165], v177 offset:32768
    ds_read_b64_tr_b16 v[166:167], v177 offset:34816
    s_waitcnt lgkmcnt(12)
    v_mfma_f32_32x32x16_bf16 v[96:111], v[136:139], v[32:35], v[96:111]
    ds_read_b64_tr_b16 v[168:169], v178 offset:32768
    ds_read_b64_tr_b16 v[170:171], v178 offset:34816
    v_mfma_f32_32x32x16_bf16 v[112:127], v[140:143], v[32:35], v[112:127]
    ds_read_b64_tr_b16 v[172:173], v179 offset:32768
    ds_read_b64_tr_b16 v[174:175], v179 offset:34816
    s_add_u32 s29, s28, 20480
    buffer_load_dwordx4 v[32:35], v5, s[12:15], s29 offen offset:0 sc1
    s_waitcnt vmcnt(13)
    s_waitcnt lgkmcnt(12)
    v_mfma_f32_32x32x16_bf16 v[64:79], v[144:147], v[36:39], v[64:79]
    ds_read_b64_tr_b16 v[128:129], v176 offset:36864
    ds_read_b64_tr_b16 v[130:131], v176 offset:38912
    v_mfma_f32_32x32x16_bf16 v[80:95], v[148:151], v[36:39], v[80:95]
    ds_read_b64_tr_b16 v[132:133], v177 offset:36864
    ds_read_b64_tr_b16 v[134:135], v177 offset:38912
    s_waitcnt lgkmcnt(12)
    v_mfma_f32_32x32x16_bf16 v[96:111], v[152:155], v[36:39], v[96:111]
    ds_read_b64_tr_b16 v[136:137], v178 offset:36864
    ds_read_b64_tr_b16 v[138:139], v178 offset:38912
    v_mfma_f32_32x32x16_bf16 v[112:127], v[156:159], v[36:39], v[112:127]
    ds_read_b64_tr_b16 v[140:141], v179 offset:36864
    ds_read_b64_tr_b16 v[142:143], v179 offset:38912
    buffer_load_dwordx4 v[36:39], v5, s[12:15], s29 offen offset:1024 sc1
    s_waitcnt vmcnt(13)
    s_waitcnt lgkmcnt(12)
    v_mfma_f32_32x32x16_bf16 v[64:79], v[160:163], v[40:43], v[64:79]
    ds_read_b64_tr_b16 v[144:145], v176 offset:40960
    ds_read_b64_tr_b16 v[146:147], v176 offset:43008
    v_mfma_f32_32x32x16_bf16 v[80:95], v[164:167], v[40:43], v[80:95]
    ds_read_b64_tr_b16 v[148:149], v177 offset:40960
    ds_read_b64_tr_b16 v[150:151], v177 offset:43008
    s_waitcnt lgkmcnt(12)
    v_mfma_f32_32x32x16_bf16 v[96:111], v[168:171], v[40:43], v[96:111]
    ds_read_b64_tr_b16 v[152:153], v178 offset:40960
    ds_read_b64_tr_b16 v[154:155], v178 offset:43008
    v_mfma_f32_32x32x16_bf16 v[112:127], v[172:175], v[40:43], v[112:127]
    ds_read_b64_tr_b16 v[156:157], v179 offset:40960
    ds_read_b64_tr_b16 v[158:159], v179 offset:43008
    buffer_load_dwordx4 v[40:43], v5, s[12:15], s29 offen offset:2048 sc1
    s_waitcnt vmcnt(13)
    s_waitcnt lgkmcnt(12)
    v_mfma_f32_32x32x16_bf16 v[64:79], v[128:131], v[44:47], v[64:79]
    ds_read_b64_tr_b16 v[160:161], v176 offset:45056
    ds_read_b64_tr_b16 v[162:163], v176 offset:47104
    v_mfma_f32_32x32x16_bf16 v[80:95], v[132:135], v[44:47], v[80:95]
    ds_read_b64_tr_b16 v[164:165], v177 offset:45056
    ds_read_b64_tr_b16 v[166:167], v177 offset:47104
    s_waitcnt lgkmcnt(12)
    v_mfma_f32_32x32x16_bf16 v[96:111], v[136:139], v[44:47], v[96:111]
    ds_read_b64_tr_b16 v[168:169], v178 offset:45056
    ds_read_b64_tr_b16 v[170:171], v178 offset:47104
    v_mfma_f32_32x32x16_bf16 v[112:127], v[140:143], v[44:47], v[112:127]
    ds_read_b64_tr_b16 v[172:173], v179 offset:45056
    ds_read_b64_tr_b16 v[174:175], v179 offset:47104
    buffer_load_dwordx4 v[44:47], v5, s[12:15], s29 offen offset:3072 sc1
    s_barrier
    s_waitcnt vmcnt(13)
    s_waitcnt lgkmcnt(12)
    v_mfma_f32_32x32x16_bf16 v[64:79], v[144:147], v[48:51], v[64:79]
    ds_read_b64_tr_b16 v[128:129], v180 offset:0
    ds_read_b64_tr_b16 v[130:131], v180 offset:2048
    v_mfma_f32_32x32x16_bf16 v[80:95], v[148:151], v[48:51], v[80:95]
    ds_read_b64_tr_b16 v[132:133], v181 offset:0
    ds_read_b64_tr_b16 v[134:135], v181 offset:2048
    s_waitcnt lgkmcnt(12)
    v_mfma_f32_32x32x16_bf16 v[96:111], v[152:155], v[48:51], v[96:111]
    ds_read_b64_tr_b16 v[136:137], v182 offset:0
    ds_read_b64_tr_b16 v[138:139], v182 offset:2048
    v_mfma_f32_32x32x16_bf16 v[112:127], v[156:159], v[48:51], v[112:127]
    ds_read_b64_tr_b16 v[140:141], v183 offset:0
    ds_read_b64_tr_b16 v[142:143], v183 offset:2048
    s_add_u32 s29, s28, 24576
    buffer_load_dwordx4 v[48:51], v5, s[12:15], s29 offen offset:0 sc1
    s_waitcnt vmcnt(13)
    s_waitcnt lgkmcnt(12)
    v_mfma_f32_32x32x16_bf16 v[64:79], v[160:163], v[52:55], v[64:79]
    ds_read_b64_tr_b16 v[144:145], v180 offset:4096
    ds_read_b64_tr_b16 v[146:147], v180 offset:6144
    v_mfma_f32_32x32x16_bf16 v[80:95], v[164:167], v[52:55], v[80:95]
    ds_read_b64_tr_b16 v[148:149], v181 offset:4096
    ds_read_b64_tr_b16 v[150:151], v181 offset:6144
    s_waitcnt lgkmcnt(12)
    v_mfma_f32_32x32x16_bf16 v[96:111], v[168:171], v[52:55], v[96:111]
    ds_read_b64_tr_b16 v[152:153], v182 offset:4096
    ds_read_b64_tr_b16 v[154:155], v182 offset:6144
    v_mfma_f32_32x32x16_bf16 v[112:127], v[172:175], v[52:55], v[112:127]
    ds_read_b64_tr_b16 v[156:157], v183 offset:4096
    ds_read_b64_tr_b16 v[158:159], v183 offset:6144
    buffer_load_dwordx4 v[52:55], v5, s[12:15], s29 offen offset:1024 sc1
    s_waitcnt vmcnt(13)
    s_waitcnt lgkmcnt(12)
    v_mfma_f32_32x32x16_bf16 v[64:79], v[128:131], v[56:59], v[64:79]
    ds_read_b64_tr_b16 v[160:161], v180 offset:8192
    ds_read_b64_tr_b16 v[162:163], v180 offset:10240
    v_mfma_f32_32x32x16_bf16 v[80:95], v[132:135], v[56:59], v[80:95]
    ds_read_b64_tr_b16 v[164:165], v181 offset:8192
    ds_read_b64_tr_b16 v[166:167], v181 offset:10240
    s_waitcnt lgkmcnt(12)
    v_mfma_f32_32x32x16_bf16 v[96:111], v[136:139], v[56:59], v[96:111]
    ds_read_b64_tr_b16 v[168:169], v182 offset:8192
    ds_read_b64_tr_b16 v[170:171], v182 offset:10240
    v_mfma_f32_32x32x16_bf16 v[112:127], v[140:143], v[56:59], v[112:127]
    ds_read_b64_tr_b16 v[172:173], v183 offset:8192
    ds_read_b64_tr_b16 v[174:175], v183 offset:10240
    buffer_load_dwordx4 v[56:59], v5, s[12:15], s29 offen offset:2048 sc1
    s_waitcnt vmcnt(13)
    s_waitcnt lgkmcnt(12)
    v_mfma_f32_32x32x16_bf16 v[64:79], v[144:147], v[60:63], v[64:79]
    ds_read_b64_tr_b16 v[128:129], v180 offset:12288
    ds_read_b64_tr_b16 v[130:131], v180 offset:14336
    v_mfma_f32_32x32x16_bf16 v[80:95], v[148:151], v[60:63], v[80:95]
    ds_read_b64_tr_b16 v[132:133], v181 offset:12288
    ds_read_b64_tr_b16 v[134:135], v181 offset:14336
    s_waitcnt lgkmcnt(12)
    v_mfma_f32_32x32x16_bf16 v[96:111], v[152:155], v[60:63], v[96:111]
    ds_read_b64_tr_b16 v[136:137], v182 offset:12288
    ds_read_b64_tr_b16 v[138:139], v182 offset:14336
    v_mfma_f32_32x32x16_bf16 v[112:127], v[156:159], v[60:63], v[112:127]
    ds_read_b64_tr_b16 v[140:141], v183 offset:12288
    ds_read_b64_tr_b16 v[142:143], v183 offset:14336
    buffer_load_dwordx4 v[60:63], v5, s[12:15], s29 offen offset:3072 sc1
    s_waitcnt vmcnt(13)
    s_waitcnt lgkmcnt(12)
    v_mfma_f32_32x32x16_bf16 v[64:79], v[160:163], v[8:11], v[64:79]
    ds_read_b64_tr_b16 v[144:145], v180 offset:16384
    ds_read_b64_tr_b16 v[146:147], v180 offset:18432
    v_mfma_f32_32x32x16_bf16 v[80:95], v[164:167], v[8:11], v[80:95]
    ds_read_b64_tr_b16 v[148:149], v181 offset:16384
    ds_read_b64_tr_b16 v[150:151], v181 offset:18432
    s_waitcnt lgkmcnt(12)
    v_mfma_f32_32x32x16_bf16 v[96:111], v[168:171], v[8:11], v[96:111]
    ds_read_b64_tr_b16 v[152:153], v182 offset:16384
    ds_read_b64_tr_b16 v[154:155], v182 offset:18432
    v_mfma_f32_32x32x16_bf16 v[112:127], v[172:175], v[8:11], v[112:127]
    ds_read_b64_tr_b16 v[156:157], v183 offset:16384
    ds_read_b64_tr_b16 v[158:159], v183 offset:18432
    s_add_u32 s29, s28, 28672
    buffer_load_dwordx4 v[8:11], v5, s[12:15], s29 offen offset:0 sc1
    s_waitcnt vmcnt(13)
    s_waitcnt lgkmcnt(12)
    v_mfma_f32_32x32x16_bf16 v[64:79], v[128:131], v[12:15], v[64:79]
    ds_read_b64_tr_b16 v[160:161], v180 offset:20480
    ds_read_b64_tr_b16 v[162:163], v180 offset:22528
    v_mfma_f32_32x32x16_bf16 v[80:95], v[132:135], v[12:15], v[80:95]
    ds_read_b64_tr_b16 v[164:165], v181 offset:20480
    ds_read_b64_tr_b16 v[166:167], v181 offset:22528
    s_waitcnt lgkmcnt(12)
    v_mfma_f32_32x32x16_bf16 v[96:111], v[136:139], v[12:15], v[96:111]
    ds_read_b64_tr_b16 v[168:169], v182 offset:20480
    ds_read_b64_tr_b16 v[170:171], v182 offset:22528
    v_mfma_f32_32x32x16_bf16 v[112:127], v[140:143], v[12:15], v[112:127]
    ds_read_b64_tr_b16 v[172:173], v183 offset:20480
    ds_read_b64_tr_b16 v[174:175], v183 offset:22528
    buffer_load_dwordx4 v[12:15], v5, s[12:15], s29 offen offset:1024 sc1
    s_barrier
    s_waitcnt vmcnt(13)
    s_waitcnt lgkmcnt(12)
    v_mfma_f32_32x32x16_bf16 v[64:79], v[144:147], v[16:19], v[64:79]
    ds_read_b64_tr_b16 v[128:129], v180 offset:24576
    ds_read_b64_tr_b16 v[130:131], v180 offset:26624
    v_mfma_f32_32x32x16_bf16 v[80:95], v[148:151], v[16:19], v[80:95]
    ds_read_b64_tr_b16 v[132:133], v181 offset:24576
    ds_read_b64_tr_b16 v[134:135], v181 offset:26624
    s_waitcnt lgkmcnt(12)
    v_mfma_f32_32x32x16_bf16 v[96:111], v[152:155], v[16:19], v[96:111]
    ds_read_b64_tr_b16 v[136:137], v182 offset:24576
    ds_read_b64_tr_b16 v[138:139], v182 offset:26624
    v_mfma_f32_32x32x16_bf16 v[112:127], v[156:159], v[16:19], v[112:127]
    ds_read_b64_tr_b16 v[140:141], v183 offset:24576
    ds_read_b64_tr_b16 v[142:143], v183 offset:26624
    buffer_load_dwordx4 v[16:19], v5, s[12:15], s29 offen offset:2048 sc1
    s_waitcnt vmcnt(13)
    s_waitcnt lgkmcnt(12)
    v_mfma_f32_32x32x16_bf16 v[64:79], v[160:163], v[20:23], v[64:79]
    ds_read_b64_tr_b16 v[144:145], v180 offset:28672
    ds_read_b64_tr_b16 v[146:147], v180 offset:30720
    v_mfma_f32_32x32x16_bf16 v[80:95], v[164:167], v[20:23], v[80:95]
    ds_read_b64_tr_b16 v[148:149], v181 offset:28672
    ds_read_b64_tr_b16 v[150:151], v181 offset:30720
    s_waitcnt lgkmcnt(12)
    v_mfma_f32_32x32x16_bf16 v[96:111], v[168:171], v[20:23], v[96:111]
    ds_read_b64_tr_b16 v[152:153], v182 offset:28672
    ds_read_b64_tr_b16 v[154:155], v182 offset:30720
    v_mfma_f32_32x32x16_bf16 v[112:127], v[172:175], v[20:23], v[112:127]
    ds_read_b64_tr_b16 v[156:157], v183 offset:28672
    ds_read_b64_tr_b16 v[158:159], v183 offset:30720
    buffer_load_dwordx4 v[20:23], v5, s[12:15], s29 offen offset:3072 sc1
    s_waitcnt vmcnt(13)
    s_waitcnt lgkmcnt(12)
    v_mfma_f32_32x32x16_bf16 v[64:79], v[128:131], v[24:27], v[64:79]
    ds_read_b64_tr_b16 v[160:161], v180 offset:32768
    ds_read_b64_tr_b16 v[162:163], v180 offset:34816
    v_mfma_f32_32x32x16_bf16 v[80:95], v[132:135], v[24:27], v[80:95]
    ds_read_b64_tr_b16 v[164:165], v181 offset:32768
    ds_read_b64_tr_b16 v[166:167], v181 offset:34816
    s_waitcnt lgkmcnt(12)
    v_mfma_f32_32x32x16_bf16 v[96:111], v[136:139], v[24:27], v[96:111]
    ds_read_b64_tr_b16 v[168:169], v182 offset:32768
    ds_read_b64_tr_b16 v[170:171], v182 offset:34816
    v_mfma_f32_32x32x16_bf16 v[112:127], v[140:143], v[24:27], v[112:127]
    ds_read_b64_tr_b16 v[172:173], v183 offset:32768
    ds_read_b64_tr_b16 v[174:175], v183 offset:34816
    s_add_u32 s29, s28, 32768
    buffer_load_dwordx4 v[24:27], v5, s[12:15], s29 offen offset:0 sc1
    s_waitcnt vmcnt(13)
    s_waitcnt lgkmcnt(12)
    v_mfma_f32_32x32x16_bf16 v[64:79], v[144:147], v[28:31], v[64:79]
    ds_read_b64_tr_b16 v[128:129], v180 offset:36864
    ds_read_b64_tr_b16 v[130:131], v180 offset:38912
    v_mfma_f32_32x32x16_bf16 v[80:95], v[148:151], v[28:31], v[80:95]
    ds_read_b64_tr_b16 v[132:133], v181 offset:36864
    ds_read_b64_tr_b16 v[134:135], v181 offset:38912
    s_waitcnt lgkmcnt(12)
    v_mfma_f32_32x32x16_bf16 v[96:111], v[152:155], v[28:31], v[96:111]
    ds_read_b64_tr_b16 v[136:137], v182 offset:36864
    ds_read_b64_tr_b16 v[138:139], v182 offset:38912
    v_mfma_f32_32x32x16_bf16 v[112:127], v[156:159], v[28:31], v[112:127]
    ds_read_b64_tr_b16 v[140:141], v183 offset:36864
    ds_read_b64_tr_b16 v[142:143], v183 offset:38912
    buffer_load_dwordx4 v[28:31], v5, s[12:15], s29 offen offset:1024 sc1
    s_waitcnt vmcnt(13)
    s_waitcnt lgkmcnt(12)
    v_mfma_f32_32x32x16_bf16 v[64:79], v[160:163], v[32:35], v[64:79]
    ds_read_b64_tr_b16 v[144:145], v180 offset:40960
    ds_read_b64_tr_b16 v[146:147], v180 offset:43008
    v_mfma_f32_32x32x16_bf16 v[80:95], v[164:167], v[32:35], v[80:95]
    ds_read_b64_tr_b16 v[148:149], v181 offset:40960
    ds_read_b64_tr_b16 v[150:151], v181 offset:43008
    s_waitcnt lgkmcnt(12)
    v_mfma_f32_32x32x16_bf16 v[96:111], v[168:171], v[32:35], v[96:111]
    ds_read_b64_tr_b16 v[152:153], v182 offset:40960
    ds_read_b64_tr_b16 v[154:155], v182 offset:43008
    v_mfma_f32_32x32x16_bf16 v[112:127], v[172:175], v[32:35], v[112:127]
    ds_read_b64_tr_b16 v[156:157], v183 offset:40960
    ds_read_b64_tr_b16 v[158:159], v183 offset:43008
    buffer_load_dwordx4 v[32:35], v5, s[12:15], s29 offen offset:2048 sc1
    s_waitcnt vmcnt(13)
    s_waitcnt lgkmcnt(12)
    v_mfma_f32_32x32x16_bf16 v[64:79], v[128:131], v[36:39], v[64:79]
    ds_read_b64_tr_b16 v[160:161], v180 offset:45056
    ds_read_b64_tr_b16 v[162:163], v180 offset:47104
    v_mfma_f32_32x32x16_bf16 v[80:95], v[132:135], v[36:39], v[80:95]
    ds_read_b64_tr_b16 v[164:165], v181 offset:45056
    ds_read_b64_tr_b16 v[166:167], v181 offset:47104
    s_waitcnt lgkmcnt(12)
    v_mfma_f32_32x32x16_bf16 v[96:111], v[136:139], v[36:39], v[96:111]
    ds_read_b64_tr_b16 v[168:169], v182 offset:45056
    ds_read_b64_tr_b16 v[170:171], v182 offset:47104
    v_mfma_f32_32x32x16_bf16 v[112:127], v[140:143], v[36:39], v[112:127]
    ds_read_b64_tr_b16 v[172:173], v183 offset:45056
    ds_read_b64_tr_b16 v[174:175], v183 offset:47104
    buffer_load_dwordx4 v[36:39], v5, s[12:15], s29 offen offset:3072 sc1
    s_barrier
    s_waitcnt vmcnt(13)
    s_waitcnt lgkmcnt(12)
    v_mfma_f32_32x32x16_bf16 v[64:79], v[144:147], v[40:43], v[64:79]
    ds_read_b64_tr_b16 v[128:129], v184 offset:0
    ds_read_b64_tr_b16 v[130:131], v184 offset:2048
    v_mfma_f32_32x32x16_bf16 v[80:95], v[148:151], v[40:43], v[80:95]
    ds_read_b64_tr_b16 v[132:133], v185 offset:0
    ds_read_b64_tr_b16 v[134:135], v185 offset:2048
    s_waitcnt lgkmcnt(12)
    v_mfma_f32_32x32x16_bf16 v[96:111], v[152:155], v[40:43], v[96:111]
    ds_read_b64_tr_b16 v[136:137], v186 offset:0
    ds_read_b64_tr_b16 v[138:139], v186 offset:2048
    v_mfma_f32_32x32x16_bf16 v[112:127], v[156:159], v[40:43], v[112:127]
    ds_read_b64_tr_b16 v[140:141], v187 offset:0
    ds_read_b64_tr_b16 v[142:143], v187 offset:2048
    s_add_u32 s29, s28, 36864
    buffer_load_dwordx4 v[40:43], v5, s[12:15], s29 offen offset:0 sc1
    s_waitcnt vmcnt(13)
    s_waitcnt lgkmcnt(12)
    v_mfma_f32_32x32x16_bf16 v[64:79], v[160:163], v[44:47], v[64:79]
    ds_read_b64_tr_b16 v[144:145], v184 offset:4096
    ds_read_b64_tr_b16 v[146:147], v184 offset:6144
    v_mfma_f32_32x32x16_bf16 v[80:95], v[164:167], v[44:47], v[80:95]
    ds_read_b64_tr_b16 v[148:149], v185 offset:4096
    ds_read_b64_tr_b16 v[150:151], v185 offset:6144
    s_waitcnt lgkmcnt(12)
    v_mfma_f32_32x32x16_bf16 v[96:111], v[168:171], v[44:47], v[96:111]
    ds_read_b64_tr_b16 v[152:153], v186 offset:4096
    ds_read_b64_tr_b16 v[154:155], v186 offset:6144
    v_mfma_f32_32x32x16_bf16 v[112:127], v[172:175], v[44:47], v[112:127]
    ds_read_b64_tr_b16 v[156:157], v187 offset:4096
    ds_read_b64_tr_b16 v[158:159], v187 offset:6144
    buffer_load_dwordx4 v[44:47], v5, s[12:15], s29 offen offset:1024 sc1
    s_waitcnt vmcnt(13)
    s_waitcnt lgkmcnt(12)
    v_mfma_f32_32x32x16_bf16 v[64:79], v[128:131], v[48:51], v[64:79]
    ds_read_b64_tr_b16 v[160:161], v184 offset:8192
    ds_read_b64_tr_b16 v[162:163], v184 offset:10240
    v_mfma_f32_32x32x16_bf16 v[80:95], v[132:135], v[48:51], v[80:95]
    ds_read_b64_tr_b16 v[164:165], v185 offset:8192
    ds_read_b64_tr_b16 v[166:167], v185 offset:10240
    s_waitcnt lgkmcnt(12)
    v_mfma_f32_32x32x16_bf16 v[96:111], v[136:139], v[48:51], v[96:111]
    ds_read_b64_tr_b16 v[168:169], v186 offset:8192
    ds_read_b64_tr_b16 v[170:171], v186 offset:10240
    v_mfma_f32_32x32x16_bf16 v[112:127], v[140:143], v[48:51], v[112:127]
    ds_read_b64_tr_b16 v[172:173], v187 offset:8192
    ds_read_b64_tr_b16 v[174:175], v187 offset:10240
    buffer_load_dwordx4 v[48:51], v5, s[12:15], s29 offen offset:2048 sc1
    s_waitcnt vmcnt(13)
    s_waitcnt lgkmcnt(12)
    v_mfma_f32_32x32x16_bf16 v[64:79], v[144:147], v[52:55], v[64:79]
    ds_read_b64_tr_b16 v[128:129], v184 offset:12288
    ds_read_b64_tr_b16 v[130:131], v184 offset:14336
    v_mfma_f32_32x32x16_bf16 v[80:95], v[148:151], v[52:55], v[80:95]
    ds_read_b64_tr_b16 v[132:133], v185 offset:12288
    ds_read_b64_tr_b16 v[134:135], v185 offset:14336
    s_waitcnt lgkmcnt(12)
    v_mfma_f32_32x32x16_bf16 v[96:111], v[152:155], v[52:55], v[96:111]
    ds_read_b64_tr_b16 v[136:137], v186 offset:12288
    ds_read_b64_tr_b16 v[138:139], v186 offset:14336
    v_mfma_f32_32x32x16_bf16 v[112:127], v[156:159], v[52:55], v[112:127]
    ds_read_b64_tr_b16 v[140:141], v187 offset:12288
    ds_read_b64_tr_b16 v[142:143], v187 offset:14336
    buffer_load_dwordx4 v[52:55], v5, s[12:15], s29 offen offset:3072 sc1
    s_waitcnt vmcnt(13)
    s_waitcnt lgkmcnt(12)
    v_mfma_f32_32x32x16_bf16 v[64:79], v[160:163], v[56:59], v[64:79]
    ds_read_b64_tr_b16 v[144:145], v184 offset:16384
    ds_read_b64_tr_b16 v[146:147], v184 offset:18432
    v_mfma_f32_32x32x16_bf16 v[80:95], v[164:167], v[56:59], v[80:95]
    ds_read_b64_tr_b16 v[148:149], v185 offset:16384
    ds_read_b64_tr_b16 v[150:151], v185 offset:18432
    s_waitcnt lgkmcnt(12)
    v_mfma_f32_32x32x16_bf16 v[96:111], v[168:171], v[56:59], v[96:111]
    ds_read_b64_tr_b16 v[152:153], v186 offset:16384
    ds_read_b64_tr_b16 v[154:155], v186 offset:18432
    v_mfma_f32_32x32x16_bf16 v[112:127], v[172:175], v[56:59], v[112:127]
    ds_read_b64_tr_b16 v[156:157], v187 offset:16384
    ds_read_b64_tr_b16 v[158:159], v187 offset:18432
    s_add_u32 s29, s28, 40960
    buffer_load_dwordx4 v[56:59], v5, s[12:15], s29 offen offset:0 sc1
    s_waitcnt vmcnt(13)
    s_waitcnt lgkmcnt(12)
    v_mfma_f32_32x32x16_bf16 v[64:79], v[128:131], v[60:63], v[64:79]
    ds_read_b64_tr_b16 v[160:161], v184 offset:20480
    ds_read_b64_tr_b16 v[162:163], v184 offset:22528
    v_mfma_f32_32x32x16_bf16 v[80:95], v[132:135], v[60:63], v[80:95]
    ds_read_b64_tr_b16 v[164:165], v185 offset:20480
    ds_read_b64_tr_b16 v[166:167], v185 offset:22528
    s_waitcnt lgkmcnt(12)
    v_mfma_f32_32x32x16_bf16 v[96:111], v[136:139], v[60:63], v[96:111]
    ds_read_b64_tr_b16 v[168:169], v186 offset:20480
    ds_read_b64_tr_b16 v[170:171], v186 offset:22528
    v_mfma_f32_32x32x16_bf16 v[112:127], v[140:143], v[60:63], v[112:127]
    ds_read_b64_tr_b16 v[172:173], v187 offset:20480
    ds_read_b64_tr_b16 v[174:175], v187 offset:22528
    buffer_load_dwordx4 v[60:63], v5, s[12:15], s29 offen offset:1024 sc1
    s_barrier
    s_waitcnt vmcnt(13)
    s_waitcnt lgkmcnt(12)
    v_mfma_f32_32x32x16_bf16 v[64:79], v[144:147], v[8:11], v[64:79]
    ds_read_b64_tr_b16 v[128:129], v184 offset:24576
    ds_read_b64_tr_b16 v[130:131], v184 offset:26624
    v_mfma_f32_32x32x16_bf16 v[80:95], v[148:151], v[8:11], v[80:95]
    ds_read_b64_tr_b16 v[132:133], v185 offset:24576
    ds_read_b64_tr_b16 v[134:135], v185 offset:26624
    s_waitcnt lgkmcnt(12)
    v_mfma_f32_32x32x16_bf16 v[96:111], v[152:155], v[8:11], v[96:111]
    ds_read_b64_tr_b16 v[136:137], v186 offset:24576
    ds_read_b64_tr_b16 v[138:139], v186 offset:26624
    v_mfma_f32_32x32x16_bf16 v[112:127], v[156:159], v[8:11], v[112:127]
    ds_read_b64_tr_b16 v[140:141], v187 offset:24576
    ds_read_b64_tr_b16 v[142:143], v187 offset:26624
    buffer_load_dwordx4 v[8:11], v5, s[12:15], s29 offen offset:2048 sc1
    s_waitcnt vmcnt(13)
    s_waitcnt lgkmcnt(12)
    v_mfma_f32_32x32x16_bf16 v[64:79], v[160:163], v[12:15], v[64:79]
    ds_read_b64_tr_b16 v[144:145], v184 offset:28672
    ds_read_b64_tr_b16 v[146:147], v184 offset:30720
    v_mfma_f32_32x32x16_bf16 v[80:95], v[164:167], v[12:15], v[80:95]
    ds_read_b64_tr_b16 v[148:149], v185 offset:28672
    ds_read_b64_tr_b16 v[150:151], v185 offset:30720
    s_waitcnt lgkmcnt(12)
    v_mfma_f32_32x32x16_bf16 v[96:111], v[168:171], v[12:15], v[96:111]
    ds_read_b64_tr_b16 v[152:153], v186 offset:28672
    ds_read_b64_tr_b16 v[154:155], v186 offset:30720
    v_mfma_f32_32x32x16_bf16 v[112:127], v[172:175], v[12:15], v[112:127]
    ds_read_b64_tr_b16 v[156:157], v187 offset:28672
    ds_read_b64_tr_b16 v[158:159], v187 offset:30720
    buffer_load_dwordx4 v[12:15], v5, s[12:15], s29 offen offset:3072 sc1
    s_waitcnt vmcnt(13)
    s_waitcnt lgkmcnt(12)
    v_mfma_f32_32x32x16_bf16 v[64:79], v[128:131], v[16:19], v[64:79]
    ds_read_b64_tr_b16 v[160:161], v184 offset:32768
    ds_read_b64_tr_b16 v[162:163], v184 offset:34816
    v_mfma_f32_32x32x16_bf16 v[80:95], v[132:135], v[16:19], v[80:95]
    ds_read_b64_tr_b16 v[164:165], v185 offset:32768
    ds_read_b64_tr_b16 v[166:167], v185 offset:34816
    s_waitcnt lgkmcnt(12)
    v_mfma_f32_32x32x16_bf16 v[96:111], v[136:139], v[16:19], v[96:111]
    ds_read_b64_tr_b16 v[168:169], v186 offset:32768
    ds_read_b64_tr_b16 v[170:171], v186 offset:34816
    v_mfma_f32_32x32x16_bf16 v[112:127], v[140:143], v[16:19], v[112:127]
    ds_read_b64_tr_b16 v[172:173], v187 offset:32768
    ds_read_b64_tr_b16 v[174:175], v187 offset:34816
    s_add_u32 s29, s28, 45056
    buffer_load_dwordx4 v[16:19], v5, s[12:15], s29 offen offset:0 sc1
    s_waitcnt vmcnt(13)
    s_waitcnt lgkmcnt(12)
    v_mfma_f32_32x32x16_bf16 v[64:79], v[144:147], v[20:23], v[64:79]
    ds_read_b64_tr_b16 v[128:129], v184 offset:36864
    ds_read_b64_tr_b16 v[130:131], v184 offset:38912
    v_mfma_f32_32x32x16_bf16 v[80:95], v[148:151], v[20:23], v[80:95]
    ds_read_b64_tr_b16 v[132:133], v185 offset:36864
    ds_read_b64_tr_b16 v[134:135], v185 offset:38912
    s_waitcnt lgkmcnt(12)
    v_mfma_f32_32x32x16_bf16 v[96:111], v[152:155], v[20:23], v[96:111]
    ds_read_b64_tr_b16 v[136:137], v186 offset:36864
    ds_read_b64_tr_b16 v[138:139], v186 offset:38912
    v_mfma_f32_32x32x16_bf16 v[112:127], v[156:159], v[20:23], v[112:127]
    ds_read_b64_tr_b16 v[140:141], v187 offset:36864
    ds_read_b64_tr_b16 v[142:143], v187 offset:38912
    buffer_load_dwordx4 v[20:23], v5, s[12:15], s29 offen offset:1024 sc1
    s_waitcnt vmcnt(13)
    s_waitcnt lgkmcnt(12)
    v_mfma_f32_32x32x16_bf16 v[64:79], v[160:163], v[24:27], v[64:79]
    ds_read_b64_tr_b16 v[144:145], v184 offset:40960
    ds_read_b64_tr_b16 v[146:147], v184 offset:43008
    v_mfma_f32_32x32x16_bf16 v[80:95], v[164:167], v[24:27], v[80:95]
    ds_read_b64_tr_b16 v[148:149], v185 offset:40960
    ds_read_b64_tr_b16 v[150:151], v185 offset:43008
    s_waitcnt lgkmcnt(12)
    v_mfma_f32_32x32x16_bf16 v[96:111], v[168:171], v[24:27], v[96:111]
    ds_read_b64_tr_b16 v[152:153], v186 offset:40960
    ds_read_b64_tr_b16 v[154:155], v186 offset:43008
    v_mfma_f32_32x32x16_bf16 v[112:127], v[172:175], v[24:27], v[112:127]
    ds_read_b64_tr_b16 v[156:157], v187 offset:40960
    ds_read_b64_tr_b16 v[158:159], v187 offset:43008
    buffer_load_dwordx4 v[24:27], v5, s[12:15], s29 offen offset:2048 sc1
    s_waitcnt vmcnt(13)
    s_waitcnt lgkmcnt(12)
    v_mfma_f32_32x32x16_bf16 v[64:79], v[128:131], v[28:31], v[64:79]
    ds_read_b64_tr_b16 v[160:161], v184 offset:45056
    ds_read_b64_tr_b16 v[162:163], v184 offset:47104
    v_mfma_f32_32x32x16_bf16 v[80:95], v[132:135], v[28:31], v[80:95]
    ds_read_b64_tr_b16 v[164:165], v185 offset:45056
    ds_read_b64_tr_b16 v[166:167], v185 offset:47104
    s_waitcnt lgkmcnt(12)
    v_mfma_f32_32x32x16_bf16 v[96:111], v[136:139], v[28:31], v[96:111]
    ds_read_b64_tr_b16 v[168:169], v186 offset:45056
    ds_read_b64_tr_b16 v[170:171], v186 offset:47104
    v_mfma_f32_32x32x16_bf16 v[112:127], v[140:143], v[28:31], v[112:127]
    ds_read_b64_tr_b16 v[172:173], v187 offset:45056
    ds_read_b64_tr_b16 v[174:175], v187 offset:47104
    buffer_load_dwordx4 v[28:31], v5, s[12:15], s29 offen offset:3072 sc1
    s_barrier
    s_waitcnt vmcnt(13)
    s_waitcnt lgkmcnt(12)
    v_mfma_f32_32x32x16_bf16 v[64:79], v[144:147], v[32:35], v[64:79]
    ds_read_b64_tr_b16 v[128:129], v176 offset:0
    ds_read_b64_tr_b16 v[130:131], v176 offset:2048
    v_mfma_f32_32x32x16_bf16 v[80:95], v[148:151], v[32:35], v[80:95]
    ds_read_b64_tr_b16 v[132:133], v177 offset:0
    ds_read_b64_tr_b16 v[134:135], v177 offset:2048
    s_waitcnt lgkmcnt(12)
    v_mfma_f32_32x32x16_bf16 v[96:111], v[152:155], v[32:35], v[96:111]
    ds_read_b64_tr_b16 v[136:137], v178 offset:0
    ds_read_b64_tr_b16 v[138:139], v178 offset:2048
    v_mfma_f32_32x32x16_bf16 v[112:127], v[156:159], v[32:35], v[112:127]
    ds_read_b64_tr_b16 v[140:141], v179 offset:0
    ds_read_b64_tr_b16 v[142:143], v179 offset:2048
    s_add_u32 s29, s28, 49152
    buffer_load_dwordx4 v[32:35], v5, s[12:15], s29 offen offset:0 sc1
    s_waitcnt vmcnt(13)
    s_waitcnt lgkmcnt(12)
    v_mfma_f32_32x32x16_bf16 v[64:79], v[160:163], v[36:39], v[64:79]
    ds_read_b64_tr_b16 v[144:145], v176 offset:4096
    ds_read_b64_tr_b16 v[146:147], v176 offset:6144
    v_mfma_f32_32x32x16_bf16 v[80:95], v[164:167], v[36:39], v[80:95]
    ds_read_b64_tr_b16 v[148:149], v177 offset:4096
    ds_read_b64_tr_b16 v[150:151], v177 offset:6144
    s_waitcnt lgkmcnt(12)
    v_mfma_f32_32x32x16_bf16 v[96:111], v[168:171], v[36:39], v[96:111]
    ds_read_b64_tr_b16 v[152:153], v178 offset:4096
    ds_read_b64_tr_b16 v[154:155], v178 offset:6144
    v_mfma_f32_32x32x16_bf16 v[112:127], v[172:175], v[36:39], v[112:127]
    ds_read_b64_tr_b16 v[156:157], v179 offset:4096
    ds_read_b64_tr_b16 v[158:159], v179 offset:6144
    buffer_load_dwordx4 v[36:39], v5, s[12:15], s29 offen offset:1024 sc1
    s_waitcnt vmcnt(13)
    s_waitcnt lgkmcnt(12)
    v_mfma_f32_32x32x16_bf16 v[64:79], v[128:131], v[40:43], v[64:79]
    ds_read_b64_tr_b16 v[160:161], v176 offset:8192
    ds_read_b64_tr_b16 v[162:163], v176 offset:10240
    v_mfma_f32_32x32x16_bf16 v[80:95], v[132:135], v[40:43], v[80:95]
    ds_read_b64_tr_b16 v[164:165], v177 offset:8192
    ds_read_b64_tr_b16 v[166:167], v177 offset:10240
    s_waitcnt lgkmcnt(12)
    v_mfma_f32_32x32x16_bf16 v[96:111], v[136:139], v[40:43], v[96:111]
    ds_read_b64_tr_b16 v[168:169], v178 offset:8192
    ds_read_b64_tr_b16 v[170:171], v178 offset:10240
    v_mfma_f32_32x32x16_bf16 v[112:127], v[140:143], v[40:43], v[112:127]
    ds_read_b64_tr_b16 v[172:173], v179 offset:8192
    ds_read_b64_tr_b16 v[174:175], v179 offset:10240
    buffer_load_dwordx4 v[40:43], v5, s[12:15], s29 offen offset:2048 sc1
    s_waitcnt vmcnt(13)
    s_waitcnt lgkmcnt(12)
    v_mfma_f32_32x32x16_bf16 v[64:79], v[144:147], v[44:47], v[64:79]
    ds_read_b64_tr_b16 v[128:129], v176 offset:12288
    ds_read_b64_tr_b16 v[130:131], v176 offset:14336
    v_mfma_f32_32x32x16_bf16 v[80:95], v[148:151], v[44:47], v[80:95]
    ds_read_b64_tr_b16 v[132:133], v177 offset:12288
    ds_read_b64_tr_b16 v[134:135], v177 offset:14336
    s_waitcnt lgkmcnt(12)
    v_mfma_f32_32x32x16_bf16 v[96:111], v[152:155], v[44:47], v[96:111]
    ds_read_b64_tr_b16 v[136:137], v178 offset:12288
    ds_read_b64_tr_b16 v[138:139], v178 offset:14336
    v_mfma_f32_32x32x16_bf16 v[112:127], v[156:159], v[44:47], v[112:127]
    ds_read_b64_tr_b16 v[140:141], v179 offset:12288
    ds_read_b64_tr_b16 v[142:143], v179 offset:14336
    buffer_load_dwordx4 v[44:47], v5, s[12:15], s29 offen offset:3072 sc1
    s_waitcnt vmcnt(13)
    s_waitcnt lgkmcnt(12)
    v_mfma_f32_32x32x16_bf16 v[64:79], v[160:163], v[48:51], v[64:79]
    ds_read_b64_tr_b16 v[144:145], v176 offset:16384
    ds_read_b64_tr_b16 v[146:147], v176 offset:18432
    v_mfma_f32_32x32x16_bf16 v[80:95], v[164:167], v[48:51], v[80:95]
    ds_read_b64_tr_b16 v[148:149], v177 offset:16384
    ds_read_b64_tr_b16 v[150:151], v177 offset:18432
    s_waitcnt lgkmcnt(12)
    v_mfma_f32_32x32x16_bf16 v[96:111], v[168:171], v[48:51], v[96:111]
    ds_read_b64_tr_b16 v[152:153], v178 offset:16384
    ds_read_b64_tr_b16 v[154:155], v178 offset:18432
    v_mfma_f32_32x32x16_bf16 v[112:127], v[172:175], v[48:51], v[112:127]
    ds_read_b64_tr_b16 v[156:157], v179 offset:16384
    ds_read_b64_tr_b16 v[158:159], v179 offset:18432
    s_add_u32 s29, s28, 53248
    buffer_load_dwordx4 v[48:51], v5, s[12:15], s29 offen offset:0 sc1
    s_waitcnt vmcnt(13)
    s_waitcnt lgkmcnt(12)
    v_mfma_f32_32x32x16_bf16 v[64:79], v[128:131], v[52:55], v[64:79]
    ds_read_b64_tr_b16 v[160:161], v176 offset:20480
    ds_read_b64_tr_b16 v[162:163], v176 offset:22528
    v_mfma_f32_32x32x16_bf16 v[80:95], v[132:135], v[52:55], v[80:95]
    ds_read_b64_tr_b16 v[164:165], v177 offset:20480
    ds_read_b64_tr_b16 v[166:167], v177 offset:22528
    s_waitcnt lgkmcnt(12)
    v_mfma_f32_32x32x16_bf16 v[96:111], v[136:139], v[52:55], v[96:111]
    ds_read_b64_tr_b16 v[168:169], v178 offset:20480
    ds_read_b64_tr_b16 v[170:171], v178 offset:22528
    v_mfma_f32_32x32x16_bf16 v[112:127], v[140:143], v[52:55], v[112:127]
    ds_read_b64_tr_b16 v[172:173], v179 offset:20480
    ds_read_b64_tr_b16 v[174:175], v179 offset:22528
    buffer_load_dwordx4 v[52:55], v5, s[12:15], s29 offen offset:1024 sc1
    s_barrier
    s_waitcnt vmcnt(13)
    s_waitcnt lgkmcnt(12)
    v_mfma_f32_32x32x16_bf16 v[64:79], v[144:147], v[56:59], v[64:79]
    ds_read_b64_tr_b16 v[128:129], v176 offset:24576
    ds_read_b64_tr_b16 v[130:131], v176 offset:26624
    v_mfma_f32_32x32x16_bf16 v[80:95], v[148:151], v[56:59], v[80:95]
    ds_read_b64_tr_b16 v[132:133], v177 offset:24576
    ds_read_b64_tr_b16 v[134:135], v177 offset:26624
    s_waitcnt lgkmcnt(12)
    v_mfma_f32_32x32x16_bf16 v[96:111], v[152:155], v[56:59], v[96:111]
    ds_read_b64_tr_b16 v[136:137], v178 offset:24576
    ds_read_b64_tr_b16 v[138:139], v178 offset:26624
    v_mfma_f32_32x32x16_bf16 v[112:127], v[156:159], v[56:59], v[112:127]
    ds_read_b64_tr_b16 v[140:141], v179 offset:24576
    ds_read_b64_tr_b16 v[142:143], v179 offset:26624
    s_waitcnt vmcnt(12)
    s_waitcnt lgkmcnt(12)
    v_mfma_f32_32x32x16_bf16 v[64:79], v[160:163], v[60:63], v[64:79]
    ds_read_b64_tr_b16 v[144:145], v176 offset:28672
    ds_read_b64_tr_b16 v[146:147], v176 offset:30720
    v_mfma_f32_32x32x16_bf16 v[80:95], v[164:167], v[60:63], v[80:95]
    ds_read_b64_tr_b16 v[148:149], v177 offset:28672
    ds_read_b64_tr_b16 v[150:151], v177 offset:30720
    s_waitcnt lgkmcnt(12)
    v_mfma_f32_32x32x16_bf16 v[96:111], v[168:171], v[60:63], v[96:111]
    ds_read_b64_tr_b16 v[152:153], v178 offset:28672
    ds_read_b64_tr_b16 v[154:155], v178 offset:30720
    v_mfma_f32_32x32x16_bf16 v[112:127], v[172:175], v[60:63], v[112:127]
    ds_read_b64_tr_b16 v[156:157], v179 offset:28672
    ds_read_b64_tr_b16 v[158:159], v179 offset:30720
    s_waitcnt vmcnt(11)
    s_waitcnt lgkmcnt(12)
    v_mfma_f32_32x32x16_bf16 v[64:79], v[128:131], v[8:11], v[64:79]
    ds_read_b64_tr_b16 v[160:161], v176 offset:32768
    ds_read_b64_tr_b16 v[162:163], v176 offset:34816
    v_mfma_f32_32x32x16_bf16 v[80:95], v[132:135], v[8:11], v[80:95]
    ds_read_b64_tr_b16 v[164:165], v177 offset:32768
    ds_read_b64_tr_b16 v[166:167], v177 offset:34816
    s_waitcnt lgkmcnt(12)
    v_mfma_f32_32x32x16_bf16 v[96:111], v[136:139], v[8:11], v[96:111]
    ds_read_b64_tr_b16 v[168:169], v178 offset:32768
    ds_read_b64_tr_b16 v[170:171], v178 offset:34816
    v_mfma_f32_32x32x16_bf16 v[112:127], v[140:143], v[8:11], v[112:127]
    ds_read_b64_tr_b16 v[172:173], v179 offset:32768
    ds_read_b64_tr_b16 v[174:175], v179 offset:34816
    s_waitcnt vmcnt(10)
    s_waitcnt lgkmcnt(12)
    v_mfma_f32_32x32x16_bf16 v[64:79], v[144:147], v[12:15], v[64:79]
    ds_read_b64_tr_b16 v[128:129], v176 offset:36864
    ds_read_b64_tr_b16 v[130:131], v176 offset:38912
    v_mfma_f32_32x32x16_bf16 v[80:95], v[148:151], v[12:15], v[80:95]
    ds_read_b64_tr_b16 v[132:133], v177 offset:36864
    ds_read_b64_tr_b16 v[134:135], v177 offset:38912
    s_waitcnt lgkmcnt(12)
    v_mfma_f32_32x32x16_bf16 v[96:111], v[152:155], v[12:15], v[96:111]
    ds_read_b64_tr_b16 v[136:137], v178 offset:36864
    ds_read_b64_tr_b16 v[138:139], v178 offset:38912
    v_mfma_f32_32x32x16_bf16 v[112:127], v[156:159], v[12:15], v[112:127]
    ds_read_b64_tr_b16 v[140:141], v179 offset:36864
    ds_read_b64_tr_b16 v[142:143], v179 offset:38912
    s_waitcnt vmcnt(9)
    s_waitcnt lgkmcnt(12)
    v_mfma_f32_32x32x16_bf16 v[64:79], v[160:163], v[16:19], v[64:79]
    ds_read_b64_tr_b16 v[144:145], v176 offset:40960
    ds_read_b64_tr_b16 v[146:147], v176 offset:43008
    v_mfma_f32_32x32x16_bf16 v[80:95], v[164:167], v[16:19], v[80:95]
    ds_read_b64_tr_b16 v[148:149], v177 offset:40960
    ds_read_b64_tr_b16 v[150:151], v177 offset:43008
    s_waitcnt lgkmcnt(12)
    v_mfma_f32_32x32x16_bf16 v[96:111], v[168:171], v[16:19], v[96:111]
    ds_read_b64_tr_b16 v[152:153], v178 offset:40960
    ds_read_b64_tr_b16 v[154:155], v178 offset:43008
    v_mfma_f32_32x32x16_bf16 v[112:127], v[172:175], v[16:19], v[112:127]
    ds_read_b64_tr_b16 v[156:157], v179 offset:40960
    ds_read_b64_tr_b16 v[158:159], v179 offset:43008
    s_waitcnt vmcnt(8)
    s_waitcnt lgkmcnt(12)
    v_mfma_f32_32x32x16_bf16 v[64:79], v[128:131], v[20:23], v[64:79]
    ds_read_b64_tr_b16 v[160:161], v176 offset:45056
    ds_read_b64_tr_b16 v[162:163], v176 offset:47104
    v_mfma_f32_32x32x16_bf16 v[80:95], v[132:135], v[20:23], v[80:95]
    ds_read_b64_tr_b16 v[164:165], v177 offset:45056
    ds_read_b64_tr_b16 v[166:167], v177 offset:47104
    s_waitcnt lgkmcnt(12)
    v_mfma_f32_32x32x16_bf16 v[96:111], v[136:139], v[20:23], v[96:111]
    ds_read_b64_tr_b16 v[168:169], v178 offset:45056
    ds_read_b64_tr_b16 v[170:171], v178 offset:47104
    v_mfma_f32_32x32x16_bf16 v[112:127], v[140:143], v[20:23], v[112:127]
    ds_read_b64_tr_b16 v[172:173], v179 offset:45056
    ds_read_b64_tr_b16 v[174:175], v179 offset:47104
    s_barrier
    s_waitcnt vmcnt(7)
    s_waitcnt lgkmcnt(12)
    v_mfma_f32_32x32x16_bf16 v[64:79], v[144:147], v[24:27], v[64:79]
    ds_read_b64_tr_b16 v[188:189], v180 offset:0
    ds_read_b64_tr_b16 v[190:191], v180 offset:2048
    v_mfma_f32_32x32x16_bf16 v[80:95], v[148:151], v[24:27], v[80:95]
    ds_read_b64_tr_b16 v[192:193], v180 offset:4096
    ds_read_b64_tr_b16 v[194:195], v180 offset:6144
    s_waitcnt lgkmcnt(12)
    v_mfma_f32_32x32x16_bf16 v[96:111], v[152:155], v[24:27], v[96:111]
    ds_read_b64_tr_b16 v[196:197], v180 offset:8192
    ds_read_b64_tr_b16 v[198:199], v180 offset:10240
    v_mfma_f32_32x32x16_bf16 v[112:127], v[156:159], v[24:27], v[112:127]
    ds_read_b64_tr_b16 v[200:201], v180 offset:12288
    ds_read_b64_tr_b16 v[202:203], v180 offset:14336
    s_waitcnt vmcnt(6)
    s_waitcnt lgkmcnt(12)
    v_mfma_f32_32x32x16_bf16 v[64:79], v[160:163], v[28:31], v[64:79]
    ds_read_b64_tr_b16 v[204:205], v180 offset:16384
    ds_read_b64_tr_b16 v[206:207], v180 offset:18432
    v_mfma_f32_32x32x16_bf16 v[80:95], v[164:167], v[28:31], v[80:95]
    ds_read_b64_tr_b16 v[208:209], v180 offset:20480
    ds_read_b64_tr_b16 v[210:211], v180 offset:22528
    s_waitcnt lgkmcnt(12)
    v_mfma_f32_32x32x16_bf16 v[96:111], v[168:171], v[28:31], v[96:111]
    v_mfma_f32_32x32x16_bf16 v[112:127], v[172:175], v[28:31], v[112:127]
    s_waitcnt vmcnt(0)
    s_waitcnt lgkmcnt(0)
    v_mfma_f32_32x32x16_bf16 v[64:79], v[188:191], v[32:35], v[64:79]
    ds_read_b64_tr_b16 v[212:213], v181 offset:0
    ds_read_b64_tr_b16 v[214:215], v181 offset:2048
    ds_read_b64_tr_b16 v[216:217], v181 offset:4096
    v_mfma_f32_32x32x16_bf16 v[64:79], v[192:195], v[36:39], v[64:79]
    ds_read_b64_tr_b16 v[218:219], v181 offset:6144
    ds_read_b64_tr_b16 v[220:221], v181 offset:8192
    ds_read_b64_tr_b16 v[222:223], v181 offset:10240
    v_mfma_f32_32x32x16_bf16 v[64:79], v[196:199], v[40:43], v[64:79]
    ds_read_b64_tr_b16 v[224:225], v181 offset:12288
    ds_read_b64_tr_b16 v[226:227], v181 offset:14336
    ds_read_b64_tr_b16 v[228:229], v181 offset:16384
    v_mfma_f32_32x32x16_bf16 v[64:79], v[200:203], v[44:47], v[64:79]
    ds_read_b64_tr_b16 v[230:231], v181 offset:18432
    ds_read_b64_tr_b16 v[232:233], v181 offset:20480
    ds_read_b64_tr_b16 v[234:235], v181 offset:22528
    v_mfma_f32_32x32x16_bf16 v[64:79], v[204:207], v[48:51], v[64:79]
    v_mfma_f32_32x32x16_bf16 v[64:79], v[208:211], v[52:55], v[64:79]
    s_waitcnt lgkmcnt(0)
    v_mfma_f32_32x32x16_bf16 v[80:95], v[212:215], v[32:35], v[80:95]
    ds_read_b64_tr_b16 v[188:189], v182 offset:0
    ds_read_b64_tr_b16 v[190:191], v182 offset:2048
    ds_read_b64_tr_b16 v[192:193], v182 offset:4096
    v_mfma_f32_32x32x16_bf16 v[80:95], v[216:219], v[36:39], v[80:95]
    ds_read_b64_tr_b16 v[194:195], v182 offset:6144
    ds_read_b64_tr_b16 v[196:197], v182 offset:8192
    ds_read_b64_tr_b16 v[198:199], v182 offset:10240
    v_mfma_f32_32x32x16_bf16 v[80:95], v[220:223], v[40:43], v[80:95]
    ds_read_b64_tr_b16 v[200:201], v182 offset:12288
    ds_read_b64_tr_b16 v[202:203], v182 offset:14336
    ds_read_b64_tr_b16 v[204:205], v182 offset:16384
    v_cvt_pk_bf16_f32 v128, v64, v65
    v_cvt_pk_bf16_f32 v129, v66, v67
    v_cvt_pk_bf16_f32 v130, v68, v69
    v_mfma_f32_32x32x16_bf16 v[80:95], v[224:227], v[44:47], v[80:95]
    ds_read_b64_tr_b16 v[206:207], v182 offset:18432
    ds_read_b64_tr_b16 v[208:209], v182 offset:20480
    ds_read_b64_tr_b16 v[210:211], v182 offset:22528
    v_cvt_pk_bf16_f32 v131, v70, v71
    buffer_store_dwordx4 v[128:131], v5, s[16:19], s30 offen offset:0 sc1
    v_cvt_pk_bf16_f32 v132, v72, v73
    v_mfma_f32_32x32x16_bf16 v[80:95], v[228:231], v[48:51], v[80:95]
    v_cvt_pk_bf16_f32 v133, v74, v75
    v_cvt_pk_bf16_f32 v134, v76, v77
    v_cvt_pk_bf16_f32 v135, v78, v79
    v_mfma_f32_32x32x16_bf16 v[80:95], v[232:235], v[52:55], v[80:95]
    buffer_store_dwordx4 v[132:135], v5, s[16:19], s30 offen offset:1024 sc1
    s_waitcnt lgkmcnt(0)
    v_mfma_f32_32x32x16_bf16 v[96:111], v[188:191], v[32:35], v[96:111]
    ds_read_b64_tr_b16 v[212:213], v183 offset:0
    ds_read_b64_tr_b16 v[214:215], v183 offset:2048
    ds_read_b64_tr_b16 v[216:217], v183 offset:4096
    v_mfma_f32_32x32x16_bf16 v[96:111], v[192:195], v[36:39], v[96:111]
    ds_read_b64_tr_b16 v[218:219], v183 offset:6144
    ds_read_b64_tr_b16 v[220:221], v183 offset:8192
    ds_read_b64_tr_b16 v[222:223], v183 offset:10240
    v_mfma_f32_32x32x16_bf16 v[96:111], v[196:199], v[40:43], v[96:111]
    ds_read_b64_tr_b16 v[224:225], v183 offset:12288
    ds_read_b64_tr_b16 v[226:227], v183 offset:14336
    ds_read_b64_tr_b16 v[228:229], v183 offset:16384
    v_cvt_pk_bf16_f32 v136, v80, v81
    v_cvt_pk_bf16_f32 v137, v82, v83
    v_cvt_pk_bf16_f32 v138, v84, v85
    v_mfma_f32_32x32x16_bf16 v[96:111], v[200:203], v[44:47], v[96:111]
    ds_read_b64_tr_b16 v[230:231], v183 offset:18432
    ds_read_b64_tr_b16 v[232:233], v183 offset:20480
    ds_read_b64_tr_b16 v[234:235], v183 offset:22528
    v_cvt_pk_bf16_f32 v139, v86, v87
    buffer_store_dwordx4 v[136:139], v5, s[16:19], s30 offen offset:2048 sc1
    v_cvt_pk_bf16_f32 v140, v88, v89
    v_mfma_f32_32x32x16_bf16 v[96:111], v[204:207], v[48:51], v[96:111]
    v_cvt_pk_bf16_f32 v141, v90, v91
    v_cvt_pk_bf16_f32 v142, v92, v93
    v_cvt_pk_bf16_f32 v143, v94, v95
    v_mfma_f32_32x32x16_bf16 v[96:111], v[208:211], v[52:55], v[96:111]
    buffer_store_dwordx4 v[140:143], v5, s[16:19], s30 offen offset:3072 sc1
    s_waitcnt lgkmcnt(0)
    v_mfma_f32_32x32x16_bf16 v[112:127], v[212:215], v[32:35], v[112:127]
    v_mfma_f32_32x32x16_bf16 v[112:127], v[216:219], v[36:39], v[112:127]
    v_mfma_f32_32x32x16_bf16 v[112:127], v[220:223], v[40:43], v[112:127]
    s_nop 6
    v_cvt_pk_bf16_f32 v144, v96, v97
    v_cvt_pk_bf16_f32 v145, v98, v99
    v_cvt_pk_bf16_f32 v146, v100, v101
    v_mfma_f32_32x32x16_bf16 v[112:127], v[224:227], v[44:47], v[112:127]
    v_cvt_pk_bf16_f32 v147, v102, v103
    buffer_store_dwordx4 v[144:147], v5, s[16:19], s31 offen offset:0 sc1
    v_cvt_pk_bf16_f32 v148, v104, v105
    v_mfma_f32_32x32x16_bf16 v[112:127], v[228:231], v[48:51], v[112:127]
    v_cvt_pk_bf16_f32 v149, v106, v107
    v_cvt_pk_bf16_f32 v150, v108, v109
    v_cvt_pk_bf16_f32 v151, v110, v111
    v_mfma_f32_32x32x16_bf16 v[112:127], v[232:235], v[52:55], v[112:127]
    buffer_store_dwordx4 v[148:151], v5, s[16:19], s31 offen offset:1024 sc1
    s_nop 10
    v_cvt_pk_bf16_f32 v152, v112, v113
    v_cvt_pk_bf16_f32 v153, v114, v115
    v_cvt_pk_bf16_f32 v154, v116, v117
    v_cvt_pk_bf16_f32 v155, v118, v119
    buffer_store_dwordx4 v[152:155], v5, s[16:19], s31 offen offset:2048 sc1
    v_cvt_pk_bf16_f32 v156, v120, v121
    v_cvt_pk_bf16_f32 v157, v122, v123
    v_cvt_pk_bf16_f32 v158, v124, v125
    v_cvt_pk_bf16_f32 v159, v126, v127
    buffer_store_dwordx4 v[156:159], v5, s[16:19], s31 offen offset:3072 sc1
    s_mul_i32 s58, s25, 5
    s_add_u32 s58, s58, s10
    s_lshl_b32 s58, s58, 6
    s_add_u32 s58, s58, s32
    s_add_u32 s58, s58, 262144
    s_waitcnt vmcnt(0)
    s_mov_b32 s60, s6
    s_mov_b32 s61, s7
    s_mov_b32 s62, 524288
    s_mov_b32 s63, 0x00020000
    v_mov_b32 v246, s92
    v_mov_b32 v247, s93
    v_and_b32 v248, 63, v0
    v_lshlrev_b32 v248, 3, v248
    s_mov_b64 exec, 0xff
    buffer_store_dwordx2 v[246:247], v248, s[60:63], s58 offen sc1
    s_mov_b64 exec, -1
nofl9:
k3_start:
    v_and_b32 v1, 63, v0
    s_cmp_ge_u32 s3, 5
    s_cselect_b32 s32, 1, 0
    s_mul_i32 s33, s32, 320
    v_subrev_u32 v2, s33, v0
    v_lshlrev_b32 v5, 4, v2
    s_lshl_b32 s36, s32, 8
    s_add_u32 s36, s36, s2
    s_mul_i32 s36, s36, 5120
    v_lshrrev_b32 v3, 2, v0
    v_lshlrev_b32 v3, 4, v3
    v_lshl_add_u32 v6, v0, 5, v3
    v_add_u32 v6, 73728, v6
    v_lshlrev_b32 v7, 4, v0
    v_add_u32 v7, 96768, v7
    v_lshrrev_b32 v3, 3, v1
    v_and_b32 v2, 7, v0
    s_mov_b32 s12, s86
    s_mov_b32 s13, s87
    s_mov_b32 s14, 2621440
    s_mov_b32 s15, 0x00020000
    s_mov_b32 s16, s84
    s_mov_b32 s17, s85
    s_mov_b32 s18, 2621440
    s_mov_b32 s19, 0x00020000
    buffer_load_dwordx4 v[44:47], v5, s[12:15], s36 offen offset:0
    s_cmp_lt_u32 s3, 6
    s_cbranch_scc1 one10
    buffer_load_dwordx4 v[48:51], v5, s[12:15], s36 offen offset:2048
one10:
    s_cmp_ge_u32 s3, 4
    s_cbranch_scc1 k3_fft
    s_and_b32 s49, s3, 1
    s_mul_i32 s48, s3, 5
    s_add_u32 s48, s48, 1
    s_lshr_b32 s48, s48, 1
    s_lshl_b32 s50, s48, 7
    v_lshl_add_u32 v101, v3, 4, s50
    s_mov_b32 s28, s82
    s_mov_b32 s29, s83
    s_mov_b32 s30, 1280
    s_mov_b32 s31, 0x00020000
    s_add_u32 s24, s6, 20971520
    s_addc_u32 s25, s7, 0
    s_mov_b32 s26, 5242880
    s_mov_b32 s27, 0x00020000
    buffer_load_dwordx4 v[32:35], v101, s[28:31], 0 offen offset:0
    buffer_load_dwordx4 v[36:39], v101, s[28:31], 0 offen offset:128
    buffer_load_dwordx4 v[40:43], v101, s[28:31], 0 offen offset:256
    v_lshlrev_b32 v100, 9, v3
    v_lshl_add_u32 v100, v2, 4, v100
    s_lshr_b32 s37, s2, 2
    s_mul_i32 s37, s37, 40960
    s_and_b32 s38, s2, 3
    s_lshl_b32 s38, s38, 7
    s_add_u32 s37, s37, s38
    s_lshl_b32 s38, s48, 12
    s_add_u32 s50, s37, s38
    s_add_u32 s51, s50, 4096
    s_add_u32 s52, s50, 8192
    s_add_u32 s53, s50, 2621440
    s_add_u32 s54, s50, 2625536
    s_add_u32 s55, s50, 2629632
    v_mul_u32_u24 v4, 1280, v2
    s_mov_b32 s40, 96768
    v_add3_u32 v102, v101, v4, s40
    v_mov_b32 v104, 0xbfb8aa3b
    v_mov_b32 v106, 0x49a00000
    v_mov_b32 v96, 150536
k3_waitq:
    ds_read_b32 v97, v96
    s_waitcnt lgkmcnt(0)
    v_readfirstlane_b32 s41, v97
    s_nop 1
    s_cmp_lg_u32 s41, 0
    s_cbranch_scc1 k3_goq
    s_sleep 1
    s_branch k3_waitq
k3_goq:
    s_cmp_eq_u32 s49, 1
    s_cbranch_scc1 k3_l2
    buffer_load_dwordx4 v[24:27], v100, s[24:27], s52 offen sc1
    buffer_load_dwordx4 v[28:31], v100, s[24:27], s55 offen sc1
k3_l2:
    buffer_load_dwordx4 v[8:11], v100, s[24:27], s50 offen sc1
    buffer_load_dwordx4 v[12:15], v100, s[24:27], s53 offen sc1
    buffer_load_dwordx4 v[16:19], v100, s[24:27], s51 offen sc1
    buffer_load_dwordx4 v[20:23], v100, s[24:27], s54 offen sc1
    s_waitcnt vmcnt(4)
    v_lshlrev_b32 v108, 16, v32
    v_and_b32 v109, 0xffff0000, v32
    v_lshlrev_b32 v110, 16, v33
    v_and_b32 v111, 0xffff0000, v33
    v_lshlrev_b32 v112, 16, v34
    v_and_b32 v113, 0xffff0000, v34
    v_lshlrev_b32 v114, 16, v35
    v_and_b32 v115, 0xffff0000, v35
    v_lshlrev_b32 v116, 16, v36
    v_and_b32 v117, 0xffff0000, v36
    v_lshlrev_b32 v118, 16, v37
    v_and_b32 v119, 0xffff0000, v37
    v_lshlrev_b32 v120, 16, v38
    v_and_b32 v121, 0xffff0000, v38
    v_lshlrev_b32 v122, 16, v39
    v_and_b32 v123, 0xffff0000, v39
    v_lshlrev_b32 v124, 16, v40
    v_and_b32 v125, 0xffff0000, v40
    v_lshlrev_b32 v126, 16, v41
    v_and_b32 v127, 0xffff0000, v41
    v_lshlrev_b32 v128, 16, v42
    v_and_b32 v129, 0xffff0000, v42
    v_lshlrev_b32 v130, 16, v43
    v_and_b32 v131, 0xffff0000, v43
    v_lshlrev_b32 v52, 16, v44
    v_and_b32 v53, 0xffff0000, v44
    v_lshlrev_b32 v54, 16, v45
    v_and_b32 v55, 0xffff0000, v45
    v_lshlrev_b32 v56, 16, v46
    v_and_b32 v57, 0xffff0000, v46
    v_lshlrev_b32 v58, 16, v47
    v_and_b32 v59, 0xffff0000, v47
    s_cbranch_scc1 k3_c2
    s_waitcnt vmcnt(4)
    v_lshlrev_b32 v76, 16, v24
    v_and_b32 v77, 0xffff0000, v24
    v_lshlrev_b32 v68, 16, v28
    v_and_b32 v69, 0xffff0000, v28
    v_lshlrev_b32 v78, 16, v25
    v_and_b32 v79, 0xffff0000, v25
    v_lshlrev_b32 v70, 16, v29
    v_and_b32 v71, 0xffff0000, v29
    v_lshlrev_b32 v80, 16, v26
    v_and_b32 v81, 0xffff0000, v26
    v_lshlrev_b32 v72, 16, v30
    v_and_b32 v73, 0xffff0000, v30
    v_lshlrev_b32 v82, 16, v27
    v_and_b32 v83, 0xffff0000, v27
    v_lshlrev_b32 v74, 16, v31
    v_and_b32 v75, 0xffff0000, v31
    v_pk_add_f32 v[124:125], v[124:125], v[76:77]
    v_pk_add_f32 v[126:127], v[126:127], v[78:79]
    v_pk_add_f32 v[128:129], v[128:129], v[80:81]
    v_pk_add_f32 v[130:131], v[130:131], v[82:83]
    v_pk_add_f32 v[124:125], v[124:125], v[68:69]
    v_pk_add_f32 v[126:127], v[126:127], v[70:71]
    v_pk_add_f32 v[128:129], v[128:129], v[72:73]
    v_pk_add_f32 v[130:131], v[130:131], v[74:75]
    v_pk_mul_f32 v[68:69], v[124:125], v[104:105] op_sel_hi:[1,0]
    v_pk_mul_f32 v[70:71], v[126:127], v[104:105] op_sel_hi:[1,0]
    v_pk_mul_f32 v[72:73], v[128:129], v[104:105] op_sel_hi:[1,0]
    v_pk_mul_f32 v[74:75], v[130:131], v[104:105] op_sel_hi:[1,0]
    v_exp_f32 v68, v68
    v_exp_f32 v69, v69
    v_exp_f32 v70, v70
    v_exp_f32 v71, v71
    v_exp_f32 v72, v72
    v_exp_f32 v73, v73
    v_exp_f32 v74, v74
    v_exp_f32 v75, v75
    v_pk_fma_f32 v[68:69], v[68:69], v[106:107], v[106:107] op_sel_hi:[1,0,0]
    v_pk_fma_f32 v[70:71], v[70:71], v[106:107], v[106:107] op_sel_hi:[1,0,0]
    v_pk_fma_f32 v[72:73], v[72:73], v[106:107], v[106:107] op_sel_hi:[1,0,0]
    v_pk_fma_f32 v[74:75], v[74:75], v[106:107], v[106:107] op_sel_hi:[1,0,0]
    v_rcp_f32 v68, v68
    v_rcp_f32 v69, v69
    v_rcp_f32 v70, v70
    v_rcp_f32 v71, v71
    v_rcp_f32 v72, v72
    v_rcp_f32 v73, v73
    v_rcp_f32 v74, v74
    v_rcp_f32 v75, v75
    v_pk_mul_f32 v[124:125], v[124:125], v[68:69]
    v_pk_mul_f32 v[126:127], v[126:127], v[70:71]
    v_pk_mul_f32 v[128:129], v[128:129], v[72:73]
    v_pk_mul_f32 v[130:131], v[130:131], v[74:75]
    v_cvt_pk_bf16_f32 v40, v124, v125
    v_cvt_pk_bf16_f32 v41, v126, v127
    v_cvt_pk_bf16_f32 v42, v128, v129
    v_cvt_pk_bf16_f32 v43, v130, v131
    ds_write_b128 v102, v[40:43] offset:256
k3_c2:
    s_waitcnt vmcnt(2)
    v_lshlrev_b32 v76, 16, v8
    v_and_b32 v77, 0xffff0000, v8
    v_lshlrev_b32 v68, 16, v12
    v_and_b32 v69, 0xffff0000, v12
    v_lshlrev_b32 v78, 16, v9
    v_and_b32 v79, 0xffff0000, v9
    v_lshlrev_b32 v70, 16, v13
    v_and_b32 v71, 0xffff0000, v13
    v_lshlrev_b32 v80, 16, v10
    v_and_b32 v81, 0xffff0000, v10
    v_lshlrev_b32 v72, 16, v14
    v_and_b32 v73, 0xffff0000, v14
    v_lshlrev_b32 v82, 16, v11
    v_and_b32 v83, 0xffff0000, v11
    v_lshlrev_b32 v74, 16, v15
    v_and_b32 v75, 0xffff0000, v15
    v_pk_add_f32 v[108:109], v[108:109], v[76:77]
    v_pk_add_f32 v[110:111], v[110:111], v[78:79]
    v_pk_add_f32 v[112:113], v[112:113], v[80:81]
    v_pk_add_f32 v[114:115], v[114:115], v[82:83]
    v_pk_add_f32 v[108:109], v[108:109], v[68:69]
    v_pk_add_f32 v[110:111], v[110:111], v[70:71]
    v_pk_add_f32 v[112:113], v[112:113], v[72:73]
    v_pk_add_f32 v[114:115], v[114:115], v[74:75]
    v_pk_mul_f32 v[68:69], v[108:109], v[104:105] op_sel_hi:[1,0]
    v_pk_mul_f32 v[70:71], v[110:111], v[104:105] op_sel_hi:[1,0]
    v_pk_mul_f32 v[72:73], v[112:113], v[104:105] op_sel_hi:[1,0]
    v_pk_mul_f32 v[74:75], v[114:115], v[104:105] op_sel_hi:[1,0]
    v_exp_f32 v68, v68
    v_exp_f32 v69, v69
    v_exp_f32 v70, v70
    v_exp_f32 v71, v71
    v_exp_f32 v72, v72
    v_exp_f32 v73, v73
    v_exp_f32 v74, v74
    v_exp_f32 v75, v75
    v_pk_fma_f32 v[68:69], v[68:69], v[106:107], v[106:107] op_sel_hi:[1,0,0]
    v_pk_fma_f32 v[70:71], v[70:71], v[106:107], v[106:107] op_sel_hi:[1,0,0]
    v_pk_fma_f32 v[72:73], v[72:73], v[106:107], v[106:107] op_sel_hi:[1,0,0]
    v_pk_fma_f32 v[74:75], v[74:75], v[106:107], v[106:107] op_sel_hi:[1,0,0]
    v_rcp_f32 v68, v68
    v_rcp_f32 v69, v69
    v_rcp_f32 v70, v70
    v_rcp_f32 v71, v71
    v_rcp_f32 v72, v72
    v_rcp_f32 v73, v73
    v_rcp_f32 v74, v74
    v_rcp_f32 v75, v75
    v_pk_mul_f32 v[108:109], v[108:109], v[68:69]
    v_pk_mul_f32 v[110:111], v[110:111], v[70:71]
    v_pk_mul_f32 v[112:113], v[112:113], v[72:73]
    v_pk_mul_f32 v[114:115], v[114:115], v[74:75]
    v_cvt_pk_bf16_f32 v32, v108, v109
    v_cvt_pk_bf16_f32 v33, v110, v111
    v_cvt_pk_bf16_f32 v34, v112, v113
    v_cvt_pk_bf16_f32 v35, v114, v115
    ds_write_b128 v102, v[32:35] offset:0
    s_waitcnt vmcnt(0)
    v_lshlrev_b32 v76, 16, v16
    v_and_b32 v77, 0xffff0000, v16
    v_lshlrev_b32 v68, 16, v20
    v_and_b32 v69, 0xffff0000, v20
    v_lshlrev_b32 v78, 16, v17
    v_and_b32 v79, 0xffff0000, v17
    v_lshlrev_b32 v70, 16, v21
    v_and_b32 v71, 0xffff0000, v21
    v_lshlrev_b32 v80, 16, v18
    v_and_b32 v81, 0xffff0000, v18
    v_lshlrev_b32 v72, 16, v22
    v_and_b32 v73, 0xffff0000, v22
    v_lshlrev_b32 v82, 16, v19
    v_and_b32 v83, 0xffff0000, v19
    v_lshlrev_b32 v74, 16, v23
    v_and_b32 v75, 0xffff0000, v23
    v_pk_add_f32 v[116:117], v[116:117], v[76:77]
    v_pk_add_f32 v[118:119], v[118:119], v[78:79]
    v_pk_add_f32 v[120:121], v[120:121], v[80:81]
    v_pk_add_f32 v[122:123], v[122:123], v[82:83]
    v_pk_add_f32 v[116:117], v[116:117], v[68:69]
    v_pk_add_f32 v[118:119], v[118:119], v[70:71]
    v_pk_add_f32 v[120:121], v[120:121], v[72:73]
    v_pk_add_f32 v[122:123], v[122:123], v[74:75]
    v_pk_mul_f32 v[68:69], v[116:117], v[104:105] op_sel_hi:[1,0]
    v_pk_mul_f32 v[70:71], v[118:119], v[104:105] op_sel_hi:[1,0]
    v_pk_mul_f32 v[72:73], v[120:121], v[104:105] op_sel_hi:[1,0]
    v_pk_mul_f32 v[74:75], v[122:123], v[104:105] op_sel_hi:[1,0]
    v_exp_f32 v68, v68
    v_exp_f32 v69, v69
    v_exp_f32 v70, v70
    v_exp_f32 v71, v71
    v_exp_f32 v72, v72
    v_exp_f32 v73, v73
    v_exp_f32 v74, v74
    v_exp_f32 v75, v75
    v_pk_fma_f32 v[68:69], v[68:69], v[106:107], v[106:107] op_sel_hi:[1,0,0]
    v_pk_fma_f32 v[70:71], v[70:71], v[106:107], v[106:107] op_sel_hi:[1,0,0]
    v_pk_fma_f32 v[72:73], v[72:73], v[106:107], v[106:107] op_sel_hi:[1,0,0]
    v_pk_fma_f32 v[74:75], v[74:75], v[106:107], v[106:107] op_sel_hi:[1,0,0]
    v_rcp_f32 v68, v68
    v_rcp_f32 v69, v69
    v_rcp_f32 v70, v70
    v_rcp_f32 v71, v71
    v_rcp_f32 v72, v72
    v_rcp_f32 v73, v73
    v_rcp_f32 v74, v74
    v_rcp_f32 v75, v75
    v_pk_mul_f32 v[116:117], v[116:117], v[68:69]
    v_pk_mul_f32 v[118:119], v[118:119], v[70:71]
    v_pk_mul_f32 v[120:121], v[120:121], v[72:73]
    v_pk_mul_f32 v[122:123], v[122:123], v[74:75]
    v_cvt_pk_bf16_f32 v36, v116, v117
    v_cvt_pk_bf16_f32 v37, v118, v119
    v_cvt_pk_bf16_f32 v38, v120, v121
    v_cvt_pk_bf16_f32 v39, v122, v123
    ds_write_b128 v102, v[36:39] offset:128
    s_branch k3_fin
k3_fft:
    s_add_u32 s20, s6, 16777216
    s_addc_u32 s21, s7, 0
    s_mov_b32 s22, 2686976
    s_mov_b32 s23, 0x00020000
    v_lshlrev_b32 v103, 16, v3
    v_lshl_add_u32 v103, v2, 4, v103
    v_cmp_eq_u32 vcc, 0, v3
    v_subrev_u32 v104, 32768, v103
    v_add_u32 v4, 2621440, v103
    v_cndmask_b32 v104, v104, v4, vcc
    v_lshrrev_b32 v100, 4, v1
    v_and_b32 v101, 15, v0
    v_cvt_f32_u32 v68, v101
    v_lshlrev_b32 v3, 2, v100
    v_cvt_f32_u32 v69, v3
    v_mul_f32 v71, 0x3d000000, v68
    v_mul_f32 v70, v71, v69
    v_cos_f32 v76, v70
    v_sin_f32 v80, v70
    v_add_f32 v70, v70, v71
    v_cos_f32 v77, v70
    v_sin_f32 v81, v70
    v_add_f32 v70, v70, v71
    v_cos_f32 v78, v70
    v_sin_f32 v82, v70
    v_add_f32 v70, v70, v71
    v_cos_f32 v79, v70
    v_sin_f32 v83, v70
    v_lshlrev_b32 v72, 31, v101
    v_xor_b32 v84, v72, v76
    v_xor_b32 v88, v72, v80
    v_xor_b32 v85, v72, v77
    v_xor_b32 v89, v72, v81
    v_xor_b32 v86, v72, v78
    v_xor_b32 v90, v72, v82
    v_xor_b32 v87, v72, v79
    v_xor_b32 v91, v72, v83
    v_cvt_pk_bf16_f32 v128, v76, -v80
    v_cvt_pk_bf16_f32 v132, v80, v76
    v_cvt_pk_bf16_f32 v144, v84, v88
    v_cvt_pk_bf16_f32 v148, v88, -v84
    v_cvt_pk_bf16_f32 v129, v77, -v81
    v_cvt_pk_bf16_f32 v133, v81, v77
    v_cvt_pk_bf16_f32 v145, v85, v89
    v_cvt_pk_bf16_f32 v149, v89, -v85
    v_cvt_pk_bf16_f32 v130, v78, -v82
    v_cvt_pk_bf16_f32 v134, v82, v78
    v_cvt_pk_bf16_f32 v146, v86, v90
    v_cvt_pk_bf16_f32 v150, v90, -v86
    v_cvt_pk_bf16_f32 v131, v79, -v83
    v_cvt_pk_bf16_f32 v135, v83, v79
    v_cvt_pk_bf16_f32 v147, v87, v91
    v_cvt_pk_bf16_f32 v151, v91, -v87
    v_cvt_pk_bf16_f32 v136, v76, -v80
    v_cvt_pk_bf16_f32 v140, v80, v76
    v_cvt_pk_bf16_f32 v152, v84, v88
    v_cvt_pk_bf16_f32 v156, v88, -v84
    v_cvt_pk_bf16_f32 v137, -v77, v81
    v_cvt_pk_bf16_f32 v141, -v81, -v77
    v_cvt_pk_bf16_f32 v153, -v85, -v89
    v_cvt_pk_bf16_f32 v157, -v89, v85
    v_cvt_pk_bf16_f32 v138, v78, -v82
    v_cvt_pk_bf16_f32 v142, v82, v78
    v_cvt_pk_bf16_f32 v154, v86, v90
    v_cvt_pk_bf16_f32 v158, v90, -v86
    v_cvt_pk_bf16_f32 v139, -v79, v83
    v_cvt_pk_bf16_f32 v143, -v83, -v79
    v_cvt_pk_bf16_f32 v155, -v87, -v91
    v_cvt_pk_bf16_f32 v159, -v91, v87
    v_add_u32 v4, 0, v3
    v_cmp_gt_u32 vcc, 10, v4
    s_nop 1
    v_cndmask_b32 v92, 0, 2.0, vcc
    v_cmp_eq_u32 vcc, 0, v4
    s_nop 1
    v_cndmask_b32 v92, v92, 1.0, vcc
    v_add_u32 v4, 1, v3
    v_cmp_gt_u32 vcc, 10, v4
    s_nop 1
    v_cndmask_b32 v93, 0, 2.0, vcc
    v_add_u32 v4, 2, v3
    v_cmp_gt_u32 vcc, 10, v4
    s_nop 1
    v_cndmask_b32 v94, 0, 2.0, vcc
    v_cmp_eq_u32 vcc, 10, v4
    s_nop 1
    v_cndmask_b32 v94, v94, 1.0, vcc
    v_add_u32 v4, 3, v3
    v_cmp_gt_u32 vcc, 10, v4
    s_nop 1
    v_cndmask_b32 v95, 0, 2.0, vcc
    v_add_f32 v73, 0x41800000, v68
    v_mul_f32 v71, 0x3acccccd, v68
    v_mul_f32 v70, v71, v69
    v_cos_f32 v160, v70
    v_sin_f32 v164, v70
    v_add_f32 v70, v70, v71
    v_cos_f32 v161, v70
    v_sin_f32 v165, v70
    v_add_f32 v70, v70, v71
    v_cos_f32 v162, v70
    v_sin_f32 v166, v70
    v_add_f32 v70, v70, v71
    v_cos_f32 v163, v70
    v_sin_f32 v167, v70
    v_mul_f32 v71, 0x3d4ccccd, v68
    v_mul_f32 v70, v71, v69
    v_cos_f32 v76, v70
    v_sin_f32 v80, v70
    v_add_f32 v70, v70, v71
    v_cos_f32 v77, v70
    v_sin_f32 v81, v70
    v_add_f32 v70, v70, v71
    v_cos_f32 v78, v70
    v_sin_f32 v82, v70
    v_add_f32 v70, v70, v71
    v_cos_f32 v79, v70
    v_sin_f32 v83, v70
    v_mul_f32 v160, v160, v92
    v_mul_f32 v164, v164, v92
    v_cvt_pk_bf16_f32 v176, v76, -v80
    v_mul_f32 v161, v161, v93
    v_mul_f32 v165, v165, v93
    v_cvt_pk_bf16_f32 v177, v77, -v81
    v_mul_f32 v162, v162, v94
    v_mul_f32 v166, v166, v94
    v_cvt_pk_bf16_f32 v178, v78, -v82
    v_mul_f32 v163, v163, v95
    v_mul_f32 v167, v167, v95
    v_cvt_pk_bf16_f32 v179, v79, -v83
    v_mul_f32 v71, 0x3acccccd, v73
    v_mul_f32 v70, v71, v69
    v_cos_f32 v168, v70
    v_sin_f32 v172, v70
    v_add_f32 v70, v70, v71
    v_cos_f32 v169, v70
    v_sin_f32 v173, v70
    v_add_f32 v70, v70, v71
    v_cos_f32 v170, v70
    v_sin_f32 v174, v70
    v_add_f32 v70, v70, v71
    v_cos_f32 v171, v70
    v_sin_f32 v175, v70
    v_mul_f32 v71, 0x3d4ccccd, v73
    v_mul_f32 v70, v71, v69
    v_cos_f32 v76, v70
    v_sin_f32 v80, v70
    v_add_f32 v70, v70, v71
    v_cos_f32 v77, v70
    v_sin_f32 v81, v70
    v_add_f32 v70, v70, v71
    v_cos_f32 v78, v70
    v_sin_f32 v82, v70
    v_add_f32 v70, v70, v71
    v_cos_f32 v79, v70
    v_sin_f32 v83, v70
    v_mul_f32 v168, v168, v92
    v_mul_f32 v172, v172, v92
    v_cvt_pk_bf16_f32 v180, v76, -v80
    v_mul_f32 v169, v169, v93
    v_mul_f32 v173, v173, v93
    v_cvt_pk_bf16_f32 v181, v77, -v81
    v_mul_f32 v170, v170, v94
    v_mul_f32 v174, v174, v94
    v_cvt_pk_bf16_f32 v182, v78, -v82
    v_mul_f32 v171, v171, v95
    v_mul_f32 v175, v175, v95
    v_cvt_pk_bf16_f32 v183, v79, -v83
    v_min_u32 v3, 10, v101
    v_lshlrev_b32 v3, 4, v3
    v_mul_u32_u24 v4, 1280, v100
    v_add_u32 v3, v3, v4
    s_and_b32 s43, s3, 3
    s_lshl_b32 s41, s43, 2
    s_add_u32 s41, s41, 107008
    s_add_u32 s42, s41, 4160
    v_add_u32 v106, s41, v3
    v_sub_u32 v108, s42, v3
    v_add_u32 v107, 5248, v106
    v_add_u32 v109, 5248, v108
    v_mul_u32_u24 v102, 144, v101
    v_lshl_add_u32 v102, v100, 4, v102
    s_mul_i32 s41, s43, 2880
    s_add_u32 s41, s41, 73728
    v_add_u32 v102, s41, v102
    v_cmp_gt_u32 s[46:47], 4, v101
    v_mov_b32 v110, 150532
    s_lshl_b32 s34, s2, 7
    s_waitcnt vmcnt(0)
    v_lshlrev_b32 v52, 16, v44
    v_and_b32 v53, 0xffff0000, v44
    v_lshlrev_b32 v54, 16, v45
    v_and_b32 v55, 0xffff0000, v45
    v_lshlrev_b32 v56, 16, v46
    v_and_b32 v57, 0xffff0000, v46
    v_lshlrev_b32 v58, 16, v47
    v_and_b32 v59, 0xffff0000, v47
    s_cmp_lt_u32 s3, 6
    s_cbranch_scc1 one11
    v_lshlrev_b32 v60, 16, v48
    v_and_b32 v61, 0xffff0000, v48
    v_lshlrev_b32 v62, 16, v49
    v_and_b32 v63, 0xffff0000, v49
    v_lshlrev_b32 v64, 16, v50
    v_and_b32 v65, 0xffff0000, v50
    v_lshlrev_b32 v66, 16, v51
    v_and_b32 v67, 0xffff0000, v51
one11:
    s_cmp_lg_u32 s3, 5
    s_cbranch_scc1 k3_noq
    s_lshr_b32 s39, s2, 2
    s_lshl_b32 s39, s39, 10
    s_add_u32 s39, s39, 262144
    s_mov_b32 s60, s6
    s_mov_b32 s61, s7
    s_mov_b32 s62, 524288
    s_mov_b32 s63, 0x00020000
    v_and_b32 v70, 63, v0
    v_lshlrev_b32 v70, 6, v70
    s_mov_b32 s59, 0
    s_mov_b32 s56, 0x3ff
    s_mov_b32 s57, 0x0
    s_ff1_i32_b64 s95, s[56:57]
    s_lshl_b64 exec, 1, s95
poll12a:
    buffer_load_dwordx2 v[68:69], v70, s[60:63], s39 offen sc1
    s_waitcnt vmcnt(0)
    v_cmp_ne_u64 vcc, s[92:93], v[68:69]
    s_nop 4
    s_cbranch_vccz poll12
    s_add_u32 s59, s59, 1
    s_cmp_ge_u32 s59, 0x8000
    s_cbranch_scc1 poll12d
    s_sleep 8
    s_branch poll12a
poll12:
    s_mov_b64 exec, s[56:57]
    buffer_load_dwordx2 v[68:69], v70, s[60:63], s39 offen sc1
    s_waitcnt vmcnt(0)
    v_cmp_ne_u64 s[56:57], s[92:93], v[68:69]
    s_nop 1
    s_mov_b64 vcc, s[56:57]
    s_cbranch_vccz poll12d
    s_add_u32 s59, s59, 1
    s_cmp_ge_u32 s59, 0x8000
    s_cbranch_scc1 poll12d
    s_sleep 2
    s_branch poll12
poll12d:
    s_mov_b64 exec, -1
    v_mov_b32 v111, 1
    ds_write_b32 v110, v111 offset:4
k3_noq:
    s_cmp_lg_u32 s3, 4
    s_cbranch_scc1 k3_wait
    s_mov_b32 s60, s6
    s_mov_b32 s61, s7
    s_mov_b32 s62, 524288
    s_mov_b32 s63, 0x00020000
    s_mov_b32 s58, 17408
    v_and_b32 v72, 63, v0
    v_lshlrev_b32 v72, 6, v72
    v_add_u32 v73, 4096, v72
    s_mov_b32 s59, 0
    s_mov_b32 s56, 0x3ffff
    s_mov_b32 s57, 0x0
    s_mov_b64 s[64:65], -1
    s_ff1_i32_b64 s95, s[56:57]
    s_lshl_b64 exec, 1, s95
poll13a:
    buffer_load_dwordx2 v[68:69], v73, s[60:63], s58 offen sc1
    s_waitcnt vmcnt(0)
    v_cmp_ne_u64 vcc, s[92:93], v[68:69]
    s_nop 4
    s_cbranch_vccz poll13
    s_add_u32 s59, s59, 1
    s_cmp_ge_u32 s59, 0x8000
    s_cbranch_scc1 poll13d
    s_sleep 8
    s_branch poll13a
poll13:
    s_mov_b64 exec, s[64:65]
    s_cbranch_execz poll13s0
    buffer_load_dwordx2 v[68:69], v72, s[60:63], s58 offen sc1
poll13s0:
    s_mov_b64 exec, s[56:57]
    s_cbranch_execz poll13s1
    buffer_load_dwordx2 v[70:71], v73, s[60:63], s58 offen sc1
poll13s1:
    s_waitcnt vmcnt(0)
    s_mov_b64 exec, s[64:65]
    v_cmp_ne_u64 s[64:65], s[92:93], v[68:69]
    s_mov_b64 exec, s[56:57]
    v_cmp_ne_u64 s[56:57], s[92:93], v[70:71]
    s_mov_b64 vcc, s[64:65]
    s_nop 0
    s_or_b64 vcc, vcc, s[56:57]
    s_cbranch_vccz poll13d
    s_add_u32 s59, s59, 1
    s_cmp_ge_u32 s59, 0x8000
    s_cbranch_scc1 poll13d
    s_sleep 2
    s_branch poll13
poll13d:
    s_mov_b64 exec, -1
    s_mov_b32 m0, 107008
    s_add_u32 s35, s34, 0
    buffer_load_dwordx4 v103, s[20:23], s35 offen sc1 lds
    s_mov_b32 m0, 108032
    s_add_u32 s35, s34, 524288
    buffer_load_dwordx4 v103, s[20:23], s35 offen sc1 lds
    s_mov_b32 m0, 109056
    s_add_u32 s35, s34, 1048576
    buffer_load_dwordx4 v103, s[20:23], s35 offen sc1 lds
    s_mov_b32 m0, 110080
    s_add_u32 s35, s34, 1572864
    buffer_load_dwordx4 v103, s[20:23], s35 offen sc1 lds
    s_mov_b32 m0, 111104
    s_add_u32 s35, s34, 2097152
    buffer_load_dwordx4 v103, s[20:23], s35 offen sc1 lds
    s_mov_b32 m0, 112128
    s_add_u32 s35, s34, 0
    buffer_load_dwordx4 v104, s[20:23], s35 offen sc1 lds
    s_mov_b32 m0, 113152
    s_add_u32 s35, s34, 491520
    buffer_load_dwordx4 v103, s[20:23], s35 offen sc1 lds
    s_mov_b32 m0, 114176
    s_add_u32 s35, s34, 1015808
    buffer_load_dwordx4 v103, s[20:23], s35 offen sc1 lds
    s_mov_b32 m0, 115200
    s_add_u32 s35, s34, 1540096
    buffer_load_dwordx4 v103, s[20:23], s35 offen sc1 lds
    s_mov_b32 m0, 116224
    s_add_u32 s35, s34, 2064384
    buffer_load_dwordx4 v103, s[20:23], s35 offen sc1 lds
    s_mov_b32 m0, 117248
    s_mov_b64 exec, 0xffff
    s_add_u32 s35, s34, 2588672
    buffer_load_dwordx4 v103, s[20:23], s35 offen sc1 lds
    s_mov_b64 exec, -1
    v_mov_b32 v111, 1
    s_waitcnt vmcnt(0)
    ds_write_b32 v110, v111
    s_cmp_lg_u32 s2, 82
    s_cbranch_scc1 k3_go
    s_mov_b32 s58, 0
    s_mov_b32 s60, s6
    s_mov_b32 s61, s7
    s_mov_b32 s62, 524288
    s_mov_b32 s63, 0x00020000
    v_mov_b32 v246, s92
    v_mov_b32 v247, s93
    v_and_b32 v248, 63, v0
    v_lshlrev_b32 v248, 3, v248
    s_mov_b64 exec, 0xff
    buffer_store_dwordx2 v[246:247], v248, s[60:63], s58 offen sc1
    s_mov_b64 exec, -1
nofl14:
    s_branch k3_go
k3_wait:
    s_sleep 2
    ds_read_b32 v111, v110
    s_waitcnt lgkmcnt(0)
    v_readfirstlane_b32 s41, v111
    s_nop 1
    s_cmp_eq_u32 s41, 0
    s_cbranch_scc1 k3_wait
k3_go:
    s_waitcnt lgkmcnt(0)
    ds_read2_b32 v[112:113], v106 offset0:0 offset1:80
    ds_read2_b32 v[114:115], v106 offset0:160 offset1:240
    ds_read2_b32 v[120:121], v107 offset0:0 offset1:80
    ds_read2_b32 v[122:123], v107 offset0:160 offset1:240
    ds_read2_b32 v[116:117], v108 offset0:240 offset1:160
    ds_read2_b32 v[118:119], v108 offset0:80 offset1:0
    ds_read2_b32 v[124:125], v109 offset0:240 offset1:160
    ds_read2_b32 v[126:127], v109 offset0:80 offset1:0
    s_waitcnt lgkmcnt(6)
    v_mfma_f32_16x16x32_bf16 v[68:71], v[112:115], v[128:131], 0
    v_mfma_f32_16x16x32_bf16 v[72:75], v[112:115], v[132:135], 0
    v_mfma_f32_16x16x32_bf16 v[76:79], v[112:115], v[136:139], 0
    v_mfma_f32_16x16x32_bf16 v[80:83], v[112:115], v[140:143], 0
    s_waitcnt lgkmcnt(4)
    v_mfma_f32_16x16x32_bf16 v[84:87], v[120:123], v[128:131], 0
    v_mfma_f32_16x16x32_bf16 v[88:91], v[120:123], v[132:135], 0
    v_mfma_f32_16x16x32_bf16 v[92:95], v[120:123], v[136:139], 0
    v_mfma_f32_16x16x32_bf16 v[96:99], v[120:123], v[140:143], 0
    s_waitcnt lgkmcnt(2)
    v_mfma_f32_16x16x32_bf16 v[68:71], v[116:119], v[144:147], v[68:71]
    v_mfma_f32_16x16x32_bf16 v[72:75], v[116:119], v[148:151], v[72:75]
    v_mfma_f32_16x16x32_bf16 v[76:79], v[116:119], v[152:155], v[76:79]
    v_mfma_f32_16x16x32_bf16 v[80:83], v[116:119], v[156:159], v[80:83]
    s_waitcnt lgkmcnt(0)
    v_mfma_f32_16x16x32_bf16 v[84:87], v[124:127], v[144:147], v[84:87]
    v_mfma_f32_16x16x32_bf16 v[88:91], v[124:127], v[148:151], v[88:91]
    v_mfma_f32_16x16x32_bf16 v[92:95], v[124:127], v[152:155], v[92:95]
    v_mfma_f32_16x16x32_bf16 v[96:99], v[124:127], v[156:159], v[96:99]
    s_nop 4
    v_pk_add_f32 v[184:185], v[68:69], v[84:85]
    v_pk_add_f32 v[84:85], v[68:69], v[84:85] neg_lo:[0,1] neg_hi:[0,1]
    v_pk_add_f32 v[186:187], v[70:71], v[86:87]
    v_pk_add_f32 v[86:87], v[70:71], v[86:87] neg_lo:[0,1] neg_hi:[0,1]
    v_pk_add_f32 v[188:189], v[72:73], v[88:89]
    v_pk_add_f32 v[88:89], v[72:73], v[88:89] neg_lo:[0,1] neg_hi:[0,1]
    v_pk_add_f32 v[190:191], v[74:75], v[90:91]
    v_pk_add_f32 v[90:91], v[74:75], v[90:91] neg_lo:[0,1] neg_hi:[0,1]
    v_pk_mul_f32 v[192:193], v[188:189], v[164:165]
    v_pk_mul_f32 v[194:195], v[190:191], v[166:167]
    v_pk_mul_f32 v[188:189], v[188:189], v[160:161]
    v_pk_mul_f32 v[190:191], v[190:191], v[162:163]
    v_pk_fma_f32 v[192:193], v[184:185], v[160:161], v[192:193] neg_lo:[0,0,1] neg_hi:[0,0,1]
    v_pk_fma_f32 v[194:195], v[186:187], v[162:163], v[194:195] neg_lo:[0,0,1] neg_hi:[0,0,1]
    v_pk_fma_f32 v[188:189], v[184:185], v[164:165], v[188:189]
    v_pk_fma_f32 v[190:191], v[186:187], v[166:167], v[190:191]
    v_cvt_pk_bf16_f32 v112, v192, v188
    v_cvt_pk_bf16_f32 v113, v193, v189
    v_cvt_pk_bf16_f32 v114, v194, v190
    v_cvt_pk_bf16_f32 v115, v195, v191
    v_pk_mul_f32 v[192:193], v[88:89], v[164:165]
    v_pk_mul_f32 v[194:195], v[90:91], v[166:167]
    v_pk_mul_f32 v[88:89], v[88:89], v[160:161]
    v_pk_mul_f32 v[90:91], v[90:91], v[162:163]
    v_pk_fma_f32 v[192:193], v[84:85], v[160:161], v[192:193] neg_lo:[0,0,1] neg_hi:[0,0,1]
    v_pk_fma_f32 v[194:195], v[86:87], v[162:163], v[194:195] neg_lo:[0,0,1] neg_hi:[0,0,1]
    v_pk_fma_f32 v[88:89], v[84:85], v[164:165], v[88:89]
    v_pk_fma_f32 v[90:91], v[86:87], v[166:167], v[90:91]
    v_cvt_pk_bf16_f32 v120, v192, v88
    v_cvt_pk_bf16_f32 v121, v193, v89
    v_cvt_pk_bf16_f32 v122, v194, v90
    v_cvt_pk_bf16_f32 v123, v195, v91
    v_pk_add_f32 v[184:185], v[76:77], v[92:93]
    v_pk_add_f32 v[92:93], v[76:77], v[92:93] neg_lo:[0,1] neg_hi:[0,1]
    v_pk_add_f32 v[186:187], v[78:79], v[94:95]
    v_pk_add_f32 v[94:95], v[78:79], v[94:95] neg_lo:[0,1] neg_hi:[0,1]
    v_pk_add_f32 v[188:189], v[80:81], v[96:97]
    v_pk_add_f32 v[96:97], v[80:81], v[96:97] neg_lo:[0,1] neg_hi:[0,1]
    v_pk_add_f32 v[190:191], v[82:83], v[98:99]
    v_pk_add_f32 v[98:99], v[82:83], v[98:99] neg_lo:[0,1] neg_hi:[0,1]
    v_pk_mul_f32 v[192:193], v[188:189], v[172:173]
    v_pk_mul_f32 v[194:195], v[190:191], v[174:175]
    v_pk_mul_f32 v[188:189], v[188:189], v[168:169]
    v_pk_mul_f32 v[190:191], v[190:191], v[170:171]
    v_pk_fma_f32 v[192:193], v[184:185], v[168:169], v[192:193] neg_lo:[0,0,1] neg_hi:[0,0,1]
    v_pk_fma_f32 v[194:195], v[186:187], v[170:171], v[194:195] neg_lo:[0,0,1] neg_hi:[0,0,1]
    v_pk_fma_f32 v[188:189], v[184:185], v[172:173], v[188:189]
    v_pk_fma_f32 v[190:191], v[186:187], v[174:175], v[190:191]
    v_cvt_pk_bf16_f32 v116, v192, v188
    v_cvt_pk_bf16_f32 v117, v193, v189
    v_cvt_pk_bf16_f32 v118, v194, v190
    v_cvt_pk_bf16_f32 v119, v195, v191
    v_pk_mul_f32 v[192:193], v[96:97], v[172:173]
    v_pk_mul_f32 v[194:195], v[98:99], v[174:175]
    v_pk_mul_f32 v[96:97], v[96:97], v[168:169]
    v_pk_mul_f32 v[98:99], v[98:99], v[170:171]
    v_pk_fma_f32 v[192:193], v[92:93], v[168:169], v[192:193] neg_lo:[0,0,1] neg_hi:[0,0,1]
    v_pk_fma_f32 v[194:195], v[94:95], v[170:171], v[194:195] neg_lo:[0,0,1] neg_hi:[0,0,1]
    v_pk_fma_f32 v[96:97], v[92:93], v[172:173], v[96:97]
    v_pk_fma_f32 v[98:99], v[94:95], v[174:175], v[98:99]
    v_cvt_pk_bf16_f32 v124, v192, v96
    v_cvt_pk_bf16_f32 v125, v193, v97
    v_cvt_pk_bf16_f32 v126, v194, v98
    v_cvt_pk_bf16_f32 v127, v195, v99
    v_mfma_f32_16x16x32_bf16 v[128:131], v[112:115], v[176:179], 0
    v_mfma_f32_16x16x32_bf16 v[132:135], v[116:119], v[176:179], 0
    v_mfma_f32_16x16x32_bf16 v[136:139], v[120:123], v[176:179], 0
    v_mfma_f32_16x16x32_bf16 v[140:143], v[124:127], v[176:179], 0
    v_mfma_f32_16x16x32_bf16 v[144:147], v[112:115], v[180:183], 0
    v_mfma_f32_16x16x32_bf16 v[148:151], v[116:119], v[180:183], 0
    v_mfma_f32_16x16x32_bf16 v[152:155], v[120:123], v[180:183], 0
    v_mfma_f32_16x16x32_bf16 v[156:159], v[124:127], v[180:183], 0
    s_nop 0
    ds_write_b128 v102, v[128:131] offset:0
    ds_write_b128 v102, v[132:135] offset:64
    ds_write_b128 v102, v[136:139] offset:11520
    ds_write_b128 v102, v[140:143] offset:11584
    s_mov_b64 exec, s[46:47]
    ds_write_b128 v102, v[144:147] offset:2304
    ds_write_b128 v102, v[148:151] offset:2368
    ds_write_b128 v102, v[152:155] offset:13824
    ds_write_b128 v102, v[156:159] offset:13888
    s_mov_b64 exec, -1
k3_fin:
    s_waitcnt lgkmcnt(0)
    s_barrier
    ds_read_b128 v[44:47], v7 offset:0
    ds_read_b128 v[8:11], v6 offset:0
    ds_read_b128 v[12:15], v6 offset:16
    s_cmp_lt_u32 s3, 6
    s_cbranch_scc1 one15
    ds_read_b128 v[48:51], v7 offset:2048
    ds_read_b128 v[16:19], v6 offset:4608
    ds_read_b128 v[20:23], v6 offset:4624
one15:
    s_waitcnt lgkmcnt(0)
    v_lshlrev_b32 v68, 16, v44
    v_and_b32 v69, 0xffff0000, v44
    v_lshlrev_b32 v70, 16, v45
    v_and_b32 v71, 0xffff0000, v45
    v_lshlrev_b32 v72, 16, v46
    v_and_b32 v73, 0xffff0000, v46
    v_lshlrev_b32 v74, 16, v47
    v_and_b32 v75, 0xffff0000, v47
    v_pk_fma_f32 v[52:53], v[8:9], v[68:69], v[52:53]
    v_pk_fma_f32 v[54:55], v[10:11], v[70:71], v[54:55]
    v_pk_fma_f32 v[56:57], v[12:13], v[72:73], v[56:57]
    v_pk_fma_f32 v[58:59], v[14:15], v[74:75], v[58:59]
    v_cvt_pk_bf16_f32 v32, v52, v53
    v_cvt_pk_bf16_f32 v33, v54, v55
    v_cvt_pk_bf16_f32 v34, v56, v57
    v_cvt_pk_bf16_f32 v35, v58, v59
    buffer_store_dwordx4 v[32:35], v5, s[16:19], s36 offen offset:0 sc1
    s_cmp_lt_u32 s3, 6
    s_cbranch_scc1 one16
    v_lshlrev_b32 v68, 16, v48
    v_and_b32 v69, 0xffff0000, v48
    v_lshlrev_b32 v70, 16, v49
    v_and_b32 v71, 0xffff0000, v49
    v_lshlrev_b32 v72, 16, v50
    v_and_b32 v73, 0xffff0000, v50
    v_lshlrev_b32 v74, 16, v51
    v_and_b32 v75, 0xffff0000, v51
    v_pk_fma_f32 v[60:61], v[16:17], v[68:69], v[60:61]
    v_pk_fma_f32 v[62:63], v[18:19], v[70:71], v[62:63]
    v_pk_fma_f32 v[64:65], v[20:21], v[72:73], v[64:65]
    v_pk_fma_f32 v[66:67], v[22:23], v[74:75], v[66:67]
    v_cvt_pk_bf16_f32 v36, v60, v61
    v_cvt_pk_bf16_f32 v37, v62, v63
    v_cvt_pk_bf16_f32 v38, v64, v65
    v_cvt_pk_bf16_f32 v39, v66, v67
    buffer_store_dwordx4 v[36:39], v5, s[16:19], s36 offen offset:2048 sc1
one16:
k_end:
    s_endpgm
.p2align 8
text_end:
.section .rodata,"a"
.p2align 6
.amdhsa_kernel recurrent_scan__spectral_gfnet__dense_activation_gelu__prompt_kernel
  .amdhsa_next_free_vgpr 256
  .amdhsa_next_free_sgpr 102
  .amdhsa_accum_offset 256
  .amdhsa_group_segment_fixed_size 0
  .amdhsa_kernarg_size 88
  .amdhsa_user_sgpr_count 2
  .amdhsa_user_sgpr_kernarg_segment_ptr 1
  .amdhsa_system_sgpr_workgroup_id_x 1
  .amdhsa_float_denorm_mode_32 3
.end_amdhsa_kernel
```
